```python
import torch

def _softmax(x, axis=-1):
    return torch.softmax(x, dim=axis)
def _gelu(x):
    return torch.nn.functional.gelu(x, approximate="tanh")
def _silu(x):
    return torch.nn.functional.silu(x)
def _sigmoid(x):
    return torch.sigmoid(x)
def _layernorm(x, axis=-1, eps=1e-5):
    m = x.mean(dim=axis, keepdim=True)
    v = x.var(dim=axis, keepdim=True, unbiased=False)
    return (x - m) / torch.sqrt(v + eps)
def _scatter_add(tgt, idx, src, axis=0):
    return tgt.clone().index_add_(axis, idx, src)
def _segment_sum(src, seg, n):
    out = torch.zeros((n,) + src.shape[1:], dtype=src.dtype)
    return out.index_add_(0, seg, src)
def _pad(x, pw):
    flat = tuple(v for pair in reversed(pw) for v in pair)
    return torch.nn.functional.pad(x, flat)

kernel_name = 'standalone__paged_block_table_kv_radixattention__sampling'

def setup_inputs():

    _w = (lambda a: (lambda t: t.to(torch.bfloat16) if t.is_floating_point() else t)(torch.as_tensor(a)))
    B, H, Hkv, Dh = 8, 32, 8, 128
    Lk = 2048
    bs = 16
    nb = max(2, Lk // bs)
    P = max(1, nb // 2)
    n_phys = P + B * (nb - P)
    shared = torch.arange(P, dtype=torch.int64)
    priv = P + torch.arange(B * (nb - P), dtype=torch.int64).reshape(B, nb - P)
    bt = torch.cat([torch.tile(shared[None, :], (B, 1)), priv], dim=1)
    ctx = nb * bs - (torch.arange(1, B + 1, dtype=torch.int64) * 2654435761) % max(1, (nb * bs - P * bs) // 2)
    return {
        "q": _w((lambda *s: torch.randn(*s, dtype=torch.bfloat16) * 0.8)(B, H, Dh)),
        "k_cache": _w((lambda *s: torch.randn(*s, dtype=torch.bfloat16) * 0.8)(n_phys, bs, Hkv, Dh)),
        "v_cache": _w((lambda *s: torch.randn(*s, dtype=torch.bfloat16) * 0.05)(n_phys, bs, Hkv, Dh)),
        "block_table": _w(bt.to(torch.int64)),
        "ctx_lens": _w(torch.as_tensor(ctx).to(torch.int64)),
    }

def reference(q, k_cache, v_cache, block_table, ctx_lens):
    B, H, Dh = q.shape
    n_phys, bs, Hkv, _ = k_cache.shape
    nb = block_table.shape[1]
    Lk = nb * bs
    rep = H // Hkv
    k = k_cache[block_table].reshape(B, Lk, Hkv, Dh)
    v = v_cache[block_table].reshape(B, Lk, Hkv, Dh)
    k = (lambda x, n, axis: torch.repeat_interleave(x, n, dim=axis))(k, rep, axis=2)
    v = (lambda x, n, axis: torch.repeat_interleave(x, n, dim=axis))(v, rep, axis=2)
    scores = torch.einsum("bhd,bkhd->bhk", q, k) * (Dh ** -0.5)
    pos = torch.arange(Lk)
    valid = pos[None, :] < ctx_lens[:, None]
    scores = torch.where(valid[:, None, :], scores, -1e9)
    p = _softmax(scores, axis=-1)
    return torch.einsum("bhk,bkhd->bhd", p, v)
```

```asm
; @launch grid=(256,1,1) block=(512,1,1) lds=156736
.amdgcn_target "amdgcn-amd-amdhsa--gfx950"
.text
.globl standalone__paged_block_table_kv_radixattention__sampling_kernel
.p2align 8
.type standalone__paged_block_table_kv_radixattention__sampling_kernel,@function
standalone__paged_block_table_kv_radixattention__sampling_kernel:
    s_load_dwordx16 s[4:19], s[0:1], 0
    s_cmp_ge_u32 s2, 256
    s_cbranch_scc1 L_exit
    s_getpc_b64 s[58:59]
L_pc0:
    s_lshr_b32 s74, s2, 3
    s_sub_u32 s75, s2, 186
    s_lshr_b32 s75, s75, 1
    s_cmp_ge_u32 s2, 248
    s_cselect_b32 s74, s75, s74
    s_lshl_b32 s74, s74, 5
    s_add_u32 s74, s74, L_tab-L_pc0
    v_lshrrev_b32 v2, 6, v0
    v_lshl_add_u32 v113, v2, 2, s74
    global_load_dword v238, v113, s[58:59]
    v_lshlrev_b32 v112, 7, v0
    v_min_u32 v112, L_exit-L_pc0, v112
    global_load_dword v239, v112, s[58:59]
    v_and_b32 v1, 63, v0
    v_lshlrev_b32 v253, 2, v1
    v_readfirstlane_b32 s51, v2
    s_cmp_lt_u32 s2, 64
    s_cbranch_scc1 L_bk
    s_nop 1
    s_cmp_eq_u32 s51, 3
    s_cbranch_scc1 L_st1
    s_cmp_eq_u32 s51, 2
    s_cbranch_scc1 L_st2
L_bk:
    v_and_b32 v254, 31, v1
    v_lshlrev_b32 v254, 3, v254
    v_lshrrev_b32 v252, 5, v1
    v_lshl_add_u32 v252, v252, 9, v254
    v_lshrrev_b32 v2, 4, v1
    v_and_b32 v3, 15, v1
    s_and_b32 s48, s2, 7
    s_lshr_b32 s49, s2, 3
    s_sub_u32 s57, s2, 248
    s_lshr_b32 s58, s57, 1
    s_add_u32 s58, s58, 31
    s_and_b32 s57, s57, 1
    s_lshl_b32 s57, s57, 2
    s_mov_b32 s34, 4096
    s_mov_b32 s35, 0x00020000
    s_mov_b32 s86, 32
    s_mov_b32 s87, 0x00020000
    s_lshl_b32 s60, s49, 9
    s_add_u32 s60, s60, 256
    s_cmp_lt_u32 s49, 8
    s_cselect_b32 s60, s60, 0
    s_mov_b32 s26, 18874368
    s_mov_b32 s27, 0x00020000
    s_mov_b32 s30, 18874368
    s_mov_b32 s31, 0x00020000
    s_mov_b32 s22, 65536
    s_mov_b32 s23, 0x00020000
    s_mov_b32 s38, 65536
    s_mov_b32 s39, 0x00020000
    s_mov_b32 s42, 256
    s_mov_b32 s43, 0x00020000
    s_mov_b32 s46, 3293184
    s_mov_b32 s47, 0x00020000
    v_add_u32 v112, 0, v2
    v_xor_b32 v113, v112, v3
    v_lshlrev_b32 v113, 4, v113
    v_lshl_add_u32 v4, v112, 11, v113
    v_add_u32 v112, 4, v2
    v_xor_b32 v113, v112, v3
    v_lshlrev_b32 v113, 4, v113
    v_lshl_add_u32 v7, v112, 11, v113
    v_add_u32 v112, 8, v2
    v_xor_b32 v113, v112, v3
    v_lshlrev_b32 v113, 4, v113
    v_lshl_add_u32 v12, v112, 11, v113
    v_add_u32 v112, 12, v2
    v_xor_b32 v113, v112, v3
    v_lshlrev_b32 v113, 4, v113
    v_lshl_add_u32 v0, v112, 11, v113
    s_and_b32 s74, s51, 3
    s_lshl_b32 s74, s74, 2
    v_add_u32 v142, s74, v2
    v_xor_b32 v142, v142, v3
    v_lshlrev_b32 v142, 4, v142
    v_lshl_add_u32 v142, v2, 8, v142
    s_lshl_b32 s75, s51, 10
    v_lshl_add_u32 v13, v1, 4, s75
    v_mov_b32 v144, -1
    v_mov_b32 v145, -1
    v_mov_b32 v146, -1
    v_mov_b32 v147, -1
    s_waitcnt lgkmcnt(0)
    s_mov_b32 s84, s12
    s_and_b32 s85, s13, 0xffff
    s_mov_b32 s32, s10
    s_and_b32 s33, s11, 0xffff
    buffer_load_dword v250, v253, s[84:87], 0 offen
    buffer_load_dwordx2 v[248:249], v254, s[32:35], s60 offen
    s_lshr_b32 s56, s6, 8
    s_sub_u32 s59, 1, s56
    s_and_b32 s59, s59, 3
    s_add_u32 s59, s59, s57
    s_cmp_ge_u32 s2, 248
    s_cselect_b32 s48, s59, s48
    s_cselect_b32 s49, s58, s49
    s_add_u32 s56, s56, s48
    s_and_b32 s56, s56, 3
    s_cmp_eq_u32 s56, 1
    s_cselect_b32 s91, 8, 7
    s_cselect_b32 s0, 4, 4
    s_cselect_b32 s1, 0, 4
    s_cselect_b32 s97, 35, 31
    s_cselect_b32 s61, 10, 12
    s_cselect_b32 s77, 16, 0
    s_add_u32 s62, s91, 8
    s_cmp_lt_u32 s49, 8
    s_cbranch_scc1 L_nobt
    s_cmp_lt_u32 s49, s62
    s_cselect_b32 s56, 0, 256
    buffer_load_dwordx2 v[240:241], v252, s[32:35], s56 offen offset:0
    buffer_load_dwordx2 v[242:243], v252, s[32:35], s56 offen offset:1024
    buffer_load_dwordx2 v[244:245], v252, s[32:35], s56 offen offset:2048
    buffer_load_dwordx2 v[246:247], v252, s[32:35], s56 offen offset:3072
L_nobt:
    s_sub_u32 s96, s97, s62
    s_mov_b32 s24, s6
    s_and_b32 s25, s7, 0xffff
    s_mov_b32 s28, s8
    s_and_b32 s29, s9, 0xffff
    s_mov_b32 s20, s4
    s_and_b32 s21, s5, 0xffff
    s_mov_b32 s36, s14
    s_and_b32 s37, s15, 0xffff
    s_mov_b32 s40, s16
    s_and_b32 s41, s17, 0xffff
    s_mov_b32 s44, s18
    s_and_b32 s45, s19, 0xffff
    s_mov_b32 s15, s61
    s_mov_b32 s16, s62
    s_sub_u32 s56, s49, s16
    s_add_u32 s57, s56, 16
    s_add_u32 s56, s56, 8
    s_sub_u32 s59, s49, 8
    s_lshl_b32 s58, s59, 1
    s_cmp_lt_u32 s49, s16
    s_cselect_b32 s57, s58, s57
    s_cselect_b32 s56, s59, s56
    s_lshl_b32 s57, s57, 13
    s_lshl_b32 s56, s56, 8
    s_mul_i32 s58, s48, 393216
    s_add_u32 s12, s57, s58
    s_mul_i32 s58, s48, 10240
    s_add_u32 s56, s56, s58
    s_add_u32 s13, s56, 3145728
    s_lshl_b32 s57, s51, 5
    s_add_u32 s57, s57, s13
    s_add_u32 s58, s12, 8192
    s_cmp_lt_u32 s49, 8
    s_cbranch_scc1 L_init1
    s_mov_b64 exec, 15
    buffer_store_dwordx2 v[144:145], v254, s[44:47], s57 offen sc1
    s_mov_b64 exec, -1
    buffer_store_dwordx4 v[144:147], v13, s[44:47], s12 offen sc1
    s_cmp_ge_u32 s49, s16
    s_cbranch_scc1 L_init1
    buffer_store_dwordx4 v[144:147], v13, s[44:47], s58 offen sc1
L_init1:
    s_mov_b32 s14, s51
    s_mov_b32 s17, s49
    s_mov_b64 s[92:93], 0xff
    s_lshl_b32 s56, s48, 8
    v_add_u32 v4, s56, v4
    v_add_u32 v7, s56, v7
    v_add_u32 v12, s56, v12
    v_add_u32 v0, s56, v0
    v_add_u32 v112, 0, v2
    v_lshrrev_b32 v113, 1, v3
    v_xor_b32 v113, v113, v112
    v_lshlrev_b32 v113, 1, v113
    v_and_b32 v114, 1, v3
    v_or_b32 v113, v113, v114
    v_lshlrev_b32 v113, 4, v113
    v_lshl_add_u32 v5, v112, 11, v113
    v_add_u32 v5, s56, v5
    v_add_u32 v112, 4, v2
    v_lshrrev_b32 v113, 1, v3
    v_xor_b32 v113, v113, v112
    v_lshlrev_b32 v113, 1, v113
    v_and_b32 v114, 1, v3
    v_or_b32 v113, v113, v114
    v_lshlrev_b32 v113, 4, v113
    v_lshl_add_u32 v6, v112, 11, v113
    v_add_u32 v6, s56, v6
    v_mul_u32_u24 v9, 144, v3
    v_add_u32 v9, 147456, v9
    s_lshl_b32 s57, s51, 4
    v_lshl_add_u32 v8, v2, 2, s57
    v_add_u32 v8, v8, v9
    s_lshl_b32 s57, s51, 11
    s_add_u32 s57, s57, 131072
    v_lshl_add_u32 v10, v1, 4, s57
    v_lshrrev_b32 v112, 2, v3
    v_lshl_add_u32 v112, v2, 2, v112
    v_and_b32 v113, 7, v112
    v_and_b32 v114, 3, v3
    v_lshlrev_b32 v114, 3, v114
    v_lshl_add_u32 v114, v112, 8, v114
    v_xor_b32 v115, s51, v113
    v_lshl_add_u32 v11, v115, 5, v114
    v_add_u32 v251, 65536, v11
    s_lshl_b32 s57, s48, 10
    v_lshl_add_u32 v15, v2, 8, s57
    v_mov_b32 v255, 0x8000
    s_mov_b32 s56, 65536
    v_writelane_b32 v255, s56, 0
    s_mov_b32 s56, 52429
    v_writelane_b32 v255, s56, 1
    s_mov_b32 s56, 43691
    v_writelane_b32 v255, s56, 2
    s_mov_b32 s56, 37450
    v_writelane_b32 v255, s56, 3
    s_waitcnt vmcnt(10)
    s_cmp_lt_u32 s49, 8
    s_cbranch_scc0 L_i_x
    s_waitcnt vmcnt(3)
L_i_x:
    s_cmp_lt_u32 s49, s16
    s_cbranch_scc1 L_i_y
    s_waitcnt vmcnt(9)
L_i_y:
    v_readfirstlane_b32 s81, v238
    s_lshl_b32 s74, s48, 10
    s_add_u32 m0, s75, 131072
    s_lshl_b32 s60, s51, 13
    s_mov_b32 s54, 2
    s_lshr_b32 s81, s81, s77
    s_and_b32 s80, s81, 0xe000
    s_add_u32 s74, s74, s80
    s_and_b32 s78, s81, 0x3ff
    buffer_load_dwordx4 v142, s[20:23], s74 offen lds
    s_bfe_u32 s79, s81, 0x1000a
    s_add_u32 s79, s79, s78
    s_lshl_b32 s78, s78, 15
    s_lshl_b32 s79, s79, 15
    s_bitcmp1_b32 s81, 11
    s_cbranch_scc0 L_nospec
    s_mov_b32 s54, 1
    s_add_u32 m0, s60, 0
    s_nop 0
    buffer_load_dwordx4 v4, s[24:27], s78 offen nt lds
    s_add_u32 m0, s60, 1024
    s_nop 0
    buffer_load_dwordx4 v7, s[24:27], s78 offen nt lds
    s_add_u32 m0, s60, 2048
    s_nop 0
    buffer_load_dwordx4 v12, s[24:27], s78 offen nt lds
    s_add_u32 m0, s60, 3072
    s_nop 0
    buffer_load_dwordx4 v0, s[24:27], s78 offen nt lds
    s_add_u32 m0, s60, 4096
    s_nop 0
    buffer_load_dwordx4 v4, s[24:27], s79 offen nt lds
    s_add_u32 m0, s60, 5120
    s_nop 0
    buffer_load_dwordx4 v7, s[24:27], s79 offen nt lds
    s_add_u32 m0, s60, 6144
    s_nop 0
    buffer_load_dwordx4 v12, s[24:27], s79 offen nt lds
    s_add_u32 m0, s60, 7168
    s_nop 0
    buffer_load_dwordx4 v0, s[24:27], s79 offen nt lds
    s_branch L_spdone
L_nospec:
    s_mov_b64 s[78:79], -1
L_spdone:
    s_cmp_ge_u32 s49, 8
    s_cbranch_scc1 L_item2
    s_waitcnt vmcnt(9)
    s_cmp_eq_u32 s54, 1
    s_cbranch_scc1 L_sw_F
    s_waitcnt vmcnt(1)
L_sw_F:
    v_add_u32 v131, 15, v250
    v_add_u32 v132, -1, v250
    v_cmp_gt_u32 vcc, 0x800, v132
    v_lshrrev_b32 v131, 4, v131
    v_mov_b32 v128, 0x80
    s_nop 0
    v_cndmask_b32 v128, v128, v131, vcc
    v_subrev_u32 v131, 63, v128
    v_max_i32 v131, 0, v131
    v_lshrrev_b32 v126, 1, v131
    v_subrev_u32 v131, s15, v126
    v_max_i32 v131, 0, v131
    s_mov_b32 s50, s49
    s_mov_b32 s3, s49
    v_readlane_b32 s56, v131, s49
    v_readlane_b32 s57, v126, s49
    v_readlane_b32 s89, v128, s49
    v_readlane_b32 s90, v250, s49
    s_nop 1
    s_add_u32 s6, s56, s51
    s_add_u32 s58, s6, 8
    s_sub_u32 s52, s57, s56
    v_readlane_b32 s82, v248, s6
    v_readlane_b32 s83, v249, s6
    v_readlane_b32 s64, v248, s58
    v_readlane_b32 s65, v249, s58
    s_lshl_b32 s53, s6, 1
    s_add_u32 s53, s53, 64
    s_sub_u32 s101, s52, 8
    s_add_u32 s58, s53, 1
    s_cmp_lt_u32 s58, s89
    s_cselect_b32 s83, s83, s82
    s_add_u32 s58, s53, 17
    s_cmp_lt_u32 s58, s89
    s_cselect_b32 s65, s65, s64
    s_lshl_b32 s82, s82, 15
    s_lshl_b32 s83, s83, 15
    s_lshl_b32 s64, s64, 15
    s_lshl_b32 s65, s65, 15
    s_cmp_eq_u32 s54, 0
    s_cbranch_scc1 L_norm_F
    s_mov_b32 s54, 0
    s_sub_u32 s56, s51, s3
    s_and_b32 s56, s56, 3
    s_add_u32 s56, s56, s3
    s_min_u32 s56, s56, 7
    s_lshl_b32 s56, s56, 13
    s_cmp_ge_u32 s51, 4
    s_cselect_b32 s56, s80, s56
    s_cmp_lg_u32 s56, s80
    s_cbranch_scc1 L_mis_F
    s_cmp_ge_u32 s51, s52
    s_cbranch_scc1 L_nok_F
    s_cmp_eq_u64 s[82:83], s[78:79]
    s_cbranch_scc1 L_nok_F
    s_cmp_eq_u32 s78, -1
    s_cbranch_scc1 L_noq_F
L_mis_F:
    s_waitcnt vmcnt(0)
L_norm_F:
    s_cmp_ge_u32 s51, 4
    s_cbranch_scc1 L_noq_F
    s_and_b32 s56, s51, 3
    s_lshl_b32 s56, s56, 2
    v_add_u32 v142, s56, v2
    v_xor_b32 v142, v142, v3
    v_lshl_add_u32 v142, v142, 4, v15
    s_sub_u32 s56, s51, s3
    s_and_b32 s56, s56, 3
    s_add_u32 s56, s56, s3
    s_min_u32 s56, s56, 7
    s_lshl_b32 s56, s56, 13
    s_lshl_b32 s57, s51, 10
    s_add_u32 m0, s57, 131072
    s_nop 0
    buffer_load_dwordx4 v142, s[20:23], s56 offen lds
L_noq_F:
    s_cmp_ge_u32 s51, s52
    s_cbranch_scc1 L_nok_F
    s_lshl_b32 s60, s51, 13
    s_add_u32 m0, s60, 0
    s_nop 0
    buffer_load_dwordx4 v4, s[24:27], s82 offen nt lds
    s_add_u32 m0, s60, 1024
    s_nop 0
    buffer_load_dwordx4 v7, s[24:27], s82 offen nt lds
    s_add_u32 m0, s60, 2048
    s_nop 0
    buffer_load_dwordx4 v12, s[24:27], s82 offen nt lds
    s_add_u32 m0, s60, 3072
    s_nop 0
    buffer_load_dwordx4 v0, s[24:27], s82 offen nt lds
    s_add_u32 m0, s60, 4096
    s_nop 0
    buffer_load_dwordx4 v4, s[24:27], s83 offen nt lds
    s_add_u32 m0, s60, 5120
    s_nop 0
    buffer_load_dwordx4 v7, s[24:27], s83 offen nt lds
    s_add_u32 m0, s60, 6144
    s_nop 0
    buffer_load_dwordx4 v12, s[24:27], s83 offen nt lds
    s_add_u32 m0, s60, 7168
    s_nop 0
    buffer_load_dwordx4 v0, s[24:27], s83 offen nt lds
L_nok_F:
    v_cndmask_b32 v129, 0, v131, s[92:93]
    v_cndmask_b32 v130, 0, v131, s[92:93]
    v_cmp_gt_u32 s[58:59], 3, v131
    s_nop 0
    v_add_u32_dpp v130, v130, v130 row_shr:1 row_mask:0xf bank_mask:0xf bound_ctrl:0
    s_nop 1
    v_add_u32_dpp v130, v130, v130 row_shr:2 row_mask:0xf bank_mask:0xf bound_ctrl:0
    s_nop 1
    v_add_u32_dpp v130, v130, v130 row_shr:4 row_mask:0xf bank_mask:0xf bound_ctrl:0
    s_nop 1
    v_readlane_b32 s7, v130, 3
    v_readlane_b32 s8, v130, 7
    v_cmp_lt_u32 vcc, 3, v1
    s_nop 2
    s_and_b32 s58, s58, 0x7e
    s_cselect_b32 s57, s7, 0
    s_cselect_b32 s7, s7, s8
    s_cselect_b32 s11, 15, 0xff
    s_sub_u32 s8, s8, s7
    v_mov_b32 v131, s57
    v_cndmask_b32 v131, 0, v131, vcc
    v_add3_u32 v132, s7, v1, 3
    v_add3_u32 v135, s8, v1, 3
    v_mul_u32_u24 v132, v132, v255
    v_mul_u32_u24 v135, v135, v255
    v_lshrrev_b32 v132, 18, v132
    v_lshrrev_b32 v135, 18, v135
    v_add_u32 v135, v135, v132
    v_cmp_ge_u32 vcc, s96, v135
    v_sub_u32 v134, v130, v131
    v_sub_u32 v133, v134, v129
    s_or_b32 s56, vcc_lo, 16
    s_ff1_i32_b32 s56, s56
    v_readlane_b32 s10, v132, s56
    v_readlane_b32 s55, v135, s56
    v_readlane_b32 s100, v255, s56
    s_add_u32 s9, s56, 4
    s_nop 2
    s_add_u32 s55, s55, s16
    v_mul_u32_u24 v131, s100, v133
    v_add_u32 v132, -1, v134
    v_max_i32 v132, 0, v132
    v_mul_u32_u24 v132, s100, v132
    v_lshrrev_b32 v131, 18, v131
    v_lshrrev_b32 v132, 18, v132
    v_cmp_lt_u32 vcc, 0, v129
    v_sub_u32 v135, v132, v131
    v_add_u32 v135, 1, v135
    v_cndmask_b32 v127, 0, v135, vcc
    s_cmp_eq_u32 s11, 0xff
    s_cselect_b32 s60, 0, s10
    s_cmp_gt_u32 s50, 3
    s_cselect_b32 s60, s60, 0
    v_readlane_b32 s61, v131, s50
    v_readlane_b32 s62, v127, s50
    s_nop 3
    s_add_u32 s61, s61, s60
    s_add_u32 s62, s62, s91
    s_sub_u32 s61, s61, s91
    v_lshrrev_b32 v112, 2, v3
    v_and_b32 v113, 3, v3
    s_and_b32 s56, s50, 3
    v_cmp_eq_u32 s[4:5], s56, v112
    s_lshl_b32 s56, s56, 2
    v_add_u32 v113, s56, v113
    s_lshl_b32 s56, s50, 13
    s_lshl_b32 s57, s48, 10
    s_add_u32 s56, s56, s57
    s_lshl_b32 s57, s51, 5
    s_add_u32 s56, s56, s57
    v_lshl_add_u32 v72, v2, 3, s56
    v_lshl_add_u32 v72, v3, 8, v72
    s_mul_i32 s56, s48, 393216
    s_lshl_b32 s57, s51, 10
    s_add_u32 s56, s56, s57
    v_lshl_add_u32 v116, v2, 8, s56
    v_lshl_add_u32 v116, v113, 4, v116
    s_lshr_b32 s57, s50, 2
    s_lshl_b32 s58, s57, 13
    v_lshl_add_u32 v114, v112, 14, s58
    v_add_u32 v114, v114, v116
    s_add_u32 s58, s61, 16
    s_lshl_b32 s58, s58, 13
    v_lshl_add_u32 v115, v112, 13, s58
    v_add_u32 v115, v115, v116
    s_mul_i32 s56, s48, 10240
    s_add_u32 s56, s56, 3145728
    v_lshl_add_u32 v117, v113, 3, s56
    v_lshl_add_u32 v117, v112, 8, v117
    s_lshl_b32 s57, s57, 7
    s_add_u32 s58, s61, 8
    s_lshl_b32 s58, s58, 8
    v_add_u32 v118, s57, v117
    v_add_u32 v119, s58, v117
    v_mov_b32 v116, 0x7fff0000
    s_sub_u32 s56, s91, 0
    s_sub_u32 s57, s62, 0
    v_cmp_gt_i32 vcc, s56, v112
    v_cmp_gt_i32 s[12:13], s57, v112
    v_add_u32 v124, 0, v114
    v_add_u32 v125, 0, v115
    v_cndmask_b32 v64, v125, v124, vcc
    v_cndmask_b32 v68, v119, v118, vcc
    v_cndmask_b32 v64, v116, v64, s[12:13]
    v_cndmask_b32 v68, v116, v68, s[12:13]
    s_sub_u32 s56, s91, 4
    s_sub_u32 s57, s62, 4
    v_cmp_gt_i32 vcc, s56, v112
    v_cmp_gt_i32 s[14:15], s57, v112
    v_add_u32 v124, 65536, v114
    v_add_u32 v125, 32768, v115
    v_cndmask_b32 v65, v125, v124, vcc
    v_cndmask_b32 v69, v119, v118, vcc
    v_add_u32 v69, 1024, v69
    v_cndmask_b32 v65, v116, v65, s[14:15]
    v_cndmask_b32 v69, v116, v69, s[14:15]
    s_sub_u32 s56, s91, 8
    s_sub_u32 s57, s62, 8
    v_cmp_gt_i32 vcc, s56, v112
    v_cmp_gt_i32 s[16:17], s57, v112
    v_add_u32 v124, 131072, v114
    v_add_u32 v125, 65536, v115
    v_cndmask_b32 v66, v125, v124, vcc
    v_cndmask_b32 v70, v119, v118, vcc
    v_add_u32 v70, 2048, v70
    v_cndmask_b32 v66, v116, v66, s[16:17]
    v_cndmask_b32 v70, v116, v70, s[16:17]
    s_sub_u32 s56, s91, 12
    s_sub_u32 s57, s62, 12
    v_cmp_gt_i32 vcc, s56, v112
    v_cmp_gt_i32 s[18:19], s57, v112
    v_add_u32 v124, 196608, v114
    v_add_u32 v125, 98304, v115
    v_cndmask_b32 v67, v125, v124, vcc
    v_cndmask_b32 v71, v119, v118, vcc
    v_add_u32 v71, 3072, v71
    v_cndmask_b32 v67, v116, v67, s[18:19]
    v_cndmask_b32 v71, v116, v71, s[18:19]
    s_cmp_ge_u32 s51, s52
    s_cbranch_scc1 L_idle1_F
    s_lshl_b32 s57, s53, 4
    v_lshl_add_u32 v143, v2, 2, s57
    s_and_b32 s56, s50, 3
    v_lshrrev_b32 v140, 2, v3
    v_cmp_eq_u32 vcc, s56, v140
    v_mov_b32 v140, s90
    v_mov_b32 v141, 0xceabfb8f
    v_mov_b32 v96, 0xc0000000
    v_mov_b32 v14, 0xff800000
    v_cndmask_b32 v96, v96, v140, vcc
    v_cndmask_b32 v14, v14, v141, vcc
    s_lshl_b32 s57, s51, 13
    v_add_u32 v136, 0, v2
    v_xor_b32 v136, v136, v3
    v_lshlrev_b32 v136, 4, v136
    v_lshl_add_u32 v136, v3, 8, v136
    v_add_u32 v76, s57, v136
    v_add_u32 v136, 131072, v136
    v_add_u32 v137, 4, v2
    v_xor_b32 v137, v137, v3
    v_lshlrev_b32 v137, 4, v137
    v_lshl_add_u32 v137, v3, 8, v137
    v_add_u32 v77, s57, v137
    v_add_u32 v137, 131072, v137
    v_add_u32 v138, 8, v2
    v_xor_b32 v138, v138, v3
    v_lshlrev_b32 v138, 4, v138
    v_lshl_add_u32 v138, v3, 8, v138
    v_add_u32 v78, s57, v138
    v_add_u32 v138, 131072, v138
    v_add_u32 v139, 12, v2
    v_xor_b32 v139, v139, v3
    v_lshlrev_b32 v139, 4, v139
    v_lshl_add_u32 v139, v3, 8, v139
    v_add_u32 v79, s57, v139
    v_add_u32 v139, 131072, v139
    v_add_u32 v120, 65536, v76
    v_add_u32 v121, 65536, v77
    v_add_u32 v122, 65536, v78
    v_add_u32 v123, 65536, v79
    v_sub_u32 v112, v96, v143
    v_subrev_u32 v113, 256, v112
    s_waitcnt vmcnt(8)
    s_barrier
    ds_read_b128 v[48:51], v136
    ds_read_b128 v[52:55], v137
    ds_read_b128 v[56:59], v138
    ds_read_b128 v[60:63], v139
    s_cmp_lt_i32 s51, s101
    s_cbranch_scc1 L_f1
    s_barrier
    s_waitcnt vmcnt(0)
    s_branch L_f2
L_f1:
    s_lshl_b32 s60, s51, 13
    s_add_u32 m0, s60, 65536
    s_nop 0
    buffer_load_dwordx4 v4, s[24:27], s64 offen nt lds
    s_add_u32 m0, s60, 66560
    s_nop 0
    buffer_load_dwordx4 v7, s[24:27], s64 offen nt lds
    s_add_u32 m0, s60, 67584
    s_nop 0
    buffer_load_dwordx4 v12, s[24:27], s64 offen nt lds
    s_add_u32 m0, s60, 68608
    s_nop 0
    buffer_load_dwordx4 v0, s[24:27], s64 offen nt lds
    s_add_u32 m0, s60, 69632
    s_nop 0
    buffer_load_dwordx4 v4, s[24:27], s65 offen nt lds
    s_add_u32 m0, s60, 70656
    s_nop 0
    buffer_load_dwordx4 v7, s[24:27], s65 offen nt lds
    s_add_u32 m0, s60, 71680
    s_nop 0
    buffer_load_dwordx4 v12, s[24:27], s65 offen nt lds
    s_add_u32 m0, s60, 72704
    s_nop 0
    buffer_load_dwordx4 v0, s[24:27], s65 offen nt lds
    s_barrier
L_f2:
    s_waitcnt vmcnt(8)
    ds_read_b128 v[16:19], v76 offset:0
    ds_read_b128 v[32:35], v76 offset:4096
    ds_read_b128 v[20:23], v77 offset:0
    ds_read_b128 v[36:39], v77 offset:4096
    ds_read_b128 v[24:27], v78 offset:0
    ds_read_b128 v[40:43], v78 offset:4096
    ds_read_b128 v[28:31], v79 offset:0
    ds_read_b128 v[44:47], v79 offset:4096
    s_waitcnt lgkmcnt(0)
    s_lshl_b32 s60, s51, 13
    s_add_u32 s59, s82, 0
    s_add_u32 m0, s60, 0
    s_nop 0
    buffer_load_dwordx4 v5, s[28:31], s59 offen nt lds
    s_add_u32 s59, s82, 0
    s_add_u32 m0, s60, 1024
    s_nop 0
    buffer_load_dwordx4 v6, s[28:31], s59 offen nt lds
    s_add_u32 s59, s82, 16384
    s_add_u32 m0, s60, 2048
    s_nop 0
    buffer_load_dwordx4 v5, s[28:31], s59 offen nt lds
    s_add_u32 s59, s82, 16384
    s_add_u32 m0, s60, 3072
    s_nop 0
    buffer_load_dwordx4 v6, s[28:31], s59 offen nt lds
    s_add_u32 s59, s83, 0
    s_add_u32 m0, s60, 4096
    s_nop 0
    buffer_load_dwordx4 v5, s[28:31], s59 offen nt lds
    s_add_u32 s59, s83, 0
    s_add_u32 m0, s60, 5120
    s_nop 0
    buffer_load_dwordx4 v6, s[28:31], s59 offen nt lds
    s_add_u32 s59, s83, 16384
    s_add_u32 m0, s60, 6144
    s_nop 0
    buffer_load_dwordx4 v5, s[28:31], s59 offen nt lds
    s_add_u32 s59, s83, 16384
    s_add_u32 m0, s60, 7168
    s_nop 0
    buffer_load_dwordx4 v6, s[28:31], s59 offen nt lds
    s_lshl_b32 s57, s48, 5
    s_buffer_load_dwordx8 s[20:27], s[40:43], s57
    v_mfma_f32_16x16x32_bf16 v[80:83], v[16:19], v[48:51], 0
    v_mfma_f32_16x16x32_bf16 v[88:91], v[32:35], v[48:51], 0
    v_mfma_f32_16x16x32_bf16 v[80:83], v[20:23], v[52:55], v[80:83]
    v_mfma_f32_16x16x32_bf16 v[88:91], v[36:39], v[52:55], v[88:91]
    v_mfma_f32_16x16x32_bf16 v[80:83], v[24:27], v[56:59], v[80:83]
    v_mfma_f32_16x16x32_bf16 v[88:91], v[40:43], v[56:59], v[88:91]
    v_mfma_f32_16x16x32_bf16 v[80:83], v[28:31], v[60:63], v[80:83]
    v_mfma_f32_16x16x32_bf16 v[88:91], v[44:47], v[60:63], v[88:91]
    s_mov_b32 s56, 0x3e0293ee
    s_nop 7
    v_cmp_lt_i32 vcc, 0, v112
    v_mul_f32 v80, s56, v80
    s_nop 0
    v_cndmask_b32 v80, v14, v80, vcc
    v_cmp_lt_i32 vcc, 1, v112
    v_mul_f32 v81, s56, v81
    s_nop 0
    v_cndmask_b32 v81, v14, v81, vcc
    v_cmp_lt_i32 vcc, 2, v112
    v_mul_f32 v82, s56, v82
    s_nop 0
    v_cndmask_b32 v82, v14, v82, vcc
    v_cmp_lt_i32 vcc, 3, v112
    v_mul_f32 v83, s56, v83
    s_nop 0
    v_cndmask_b32 v83, v14, v83, vcc
    v_cmp_lt_i32 vcc, 16, v112
    v_mul_f32 v88, s56, v88
    s_nop 0
    v_cndmask_b32 v88, v14, v88, vcc
    v_cmp_lt_i32 vcc, 17, v112
    v_mul_f32 v89, s56, v89
    s_nop 0
    v_cndmask_b32 v89, v14, v89, vcc
    v_cmp_lt_i32 vcc, 18, v112
    v_mul_f32 v90, s56, v90
    s_nop 0
    v_cndmask_b32 v90, v14, v90, vcc
    v_cmp_lt_i32 vcc, 19, v112
    v_mul_f32 v91, s56, v91
    s_nop 0
    v_cndmask_b32 v91, v14, v91, vcc
    v_max3_f32 v98, v80, v81, v82
    v_max3_f32 v98, v98, v83, v88
    v_max3_f32 v98, v98, v89, v90
    v_max_f32 v98, v98, v91
    s_cmp_ge_i32 s51, s101
    s_cbranch_scc1 L_maxw_F
    s_waitcnt vmcnt(8)
    ds_read_b128 v[144:147], v120 offset:0
    ds_read_b128 v[160:163], v120 offset:4096
    ds_read_b128 v[148:151], v121 offset:0
    ds_read_b128 v[164:167], v121 offset:4096
    ds_read_b128 v[152:155], v122 offset:0
    ds_read_b128 v[168:171], v122 offset:4096
    ds_read_b128 v[156:159], v123 offset:0
    ds_read_b128 v[172:175], v123 offset:4096
    s_waitcnt lgkmcnt(0)
    v_mfma_f32_16x16x32_bf16 v[84:87], v[144:147], v[48:51], 0
    v_mfma_f32_16x16x32_bf16 v[92:95], v[160:163], v[48:51], 0
    v_mfma_f32_16x16x32_bf16 v[84:87], v[148:151], v[52:55], v[84:87]
    v_mfma_f32_16x16x32_bf16 v[92:95], v[164:167], v[52:55], v[92:95]
    v_mfma_f32_16x16x32_bf16 v[84:87], v[152:155], v[56:59], v[84:87]
    v_mfma_f32_16x16x32_bf16 v[92:95], v[168:171], v[56:59], v[92:95]
    v_mfma_f32_16x16x32_bf16 v[84:87], v[156:159], v[60:63], v[84:87]
    v_mfma_f32_16x16x32_bf16 v[92:95], v[172:175], v[60:63], v[92:95]
    s_nop 7
    v_cmp_lt_i32 vcc, 0, v113
    v_mul_f32 v84, s56, v84
    s_nop 0
    v_cndmask_b32 v84, v14, v84, vcc
    v_cmp_lt_i32 vcc, 1, v113
    v_mul_f32 v85, s56, v85
    s_nop 0
    v_cndmask_b32 v85, v14, v85, vcc
    v_cmp_lt_i32 vcc, 2, v113
    v_mul_f32 v86, s56, v86
    s_nop 0
    v_cndmask_b32 v86, v14, v86, vcc
    v_cmp_lt_i32 vcc, 3, v113
    v_mul_f32 v87, s56, v87
    s_nop 0
    v_cndmask_b32 v87, v14, v87, vcc
    v_cmp_lt_i32 vcc, 16, v113
    v_mul_f32 v92, s56, v92
    s_nop 0
    v_cndmask_b32 v92, v14, v92, vcc
    v_cmp_lt_i32 vcc, 17, v113
    v_mul_f32 v93, s56, v93
    s_nop 0
    v_cndmask_b32 v93, v14, v93, vcc
    v_cmp_lt_i32 vcc, 18, v113
    v_mul_f32 v94, s56, v94
    s_nop 0
    v_cndmask_b32 v94, v14, v94, vcc
    v_cmp_lt_i32 vcc, 19, v113
    v_mul_f32 v95, s56, v95
    s_nop 0
    v_cndmask_b32 v95, v14, v95, vcc
    v_max3_f32 v98, v98, v84, v85
    v_max3_f32 v98, v98, v86, v87
    v_max3_f32 v98, v98, v92, v93
    v_max3_f32 v98, v98, v94, v95
    s_branch L_maxw_F
L_idle1_F:
    s_waitcnt vmcnt(0)
    s_barrier
    s_barrier
    s_lshl_b32 s57, s48, 5
    s_buffer_load_dwordx8 s[20:27], s[40:43], s57
    v_mov_b32 v98, 0xff800000
L_maxw_F:
    ds_write_b32 v8, v98
    s_waitcnt lgkmcnt(0)
    s_barrier
    ds_read_b128 v[112:115], v9 offset:0
    ds_read_b128 v[116:119], v9 offset:16
    ds_read_b128 v[120:123], v9 offset:32
    ds_read_b128 v[124:127], v9 offset:48
    ds_read_b128 v[128:131], v9 offset:64
    ds_read_b128 v[132:135], v9 offset:80
    ds_read_b128 v[136:139], v9 offset:96
    ds_read_b128 v[140:143], v9 offset:112
    s_waitcnt lgkmcnt(0)
    v_max3_f32 v98, v112, v113, v114
    v_max3_f32 v98, v98, v115, v116
    v_max3_f32 v98, v98, v117, v118
    v_max3_f32 v98, v98, v119, v120
    v_max3_f32 v98, v98, v121, v122
    v_max3_f32 v98, v98, v123, v124
    v_max3_f32 v98, v98, v125, v126
    v_max3_f32 v98, v98, v127, v128
    v_max3_f32 v98, v98, v129, v130
    v_max3_f32 v98, v98, v131, v132
    v_max3_f32 v98, v98, v133, v134
    v_max3_f32 v98, v98, v135, v136
    v_max3_f32 v98, v98, v137, v138
    v_max3_f32 v98, v98, v139, v140
    v_max3_f32 v98, v98, v141, v142
    v_max_f32 v98, v98, v143
    v_mov_b32 v100, 0
    s_cmp_ge_u32 s51, s52
    s_cbranch_scc1 L_sumw_F
    s_cmp_lt_i32 s51, s101
    s_cbranch_scc1 L_exp2_F
    v_sub_f32 v80, v80, v98
    v_sub_f32 v81, v81, v98
    v_sub_f32 v82, v82, v98
    v_sub_f32 v83, v83, v98
    v_sub_f32 v88, v88, v98
    v_sub_f32 v89, v89, v98
    v_sub_f32 v90, v90, v98
    v_sub_f32 v91, v91, v98
    v_exp_f32 v80, v80
    v_exp_f32 v81, v81
    v_exp_f32 v82, v82
    v_exp_f32 v83, v83
    v_exp_f32 v88, v88
    v_exp_f32 v89, v89
    v_exp_f32 v90, v90
    v_exp_f32 v91, v91
    s_nop 0
    v_add_f32 v100, v80, v81
    v_add_f32 v112, v82, v83
    v_add_f32 v113, v88, v89
    v_add_f32 v114, v90, v91
    v_add_f32 v100, v100, v112
    v_add_f32 v113, v113, v114
    v_add_f32 v100, v100, v113
    v_cvt_pk_bf16_f32 v104, v80, v81
    v_cvt_pk_bf16_f32 v105, v82, v83
    v_cvt_pk_bf16_f32 v106, v88, v89
    v_cvt_pk_bf16_f32 v107, v90, v91
    ds_write_b128 v10, v[104:107] offset:0
    s_branch L_sumw_F
L_exp2_F:
    v_sub_f32 v80, v80, v98
    v_sub_f32 v81, v81, v98
    v_sub_f32 v82, v82, v98
    v_sub_f32 v83, v83, v98
    v_sub_f32 v88, v88, v98
    v_sub_f32 v89, v89, v98
    v_sub_f32 v90, v90, v98
    v_sub_f32 v91, v91, v98
    v_sub_f32 v84, v84, v98
    v_sub_f32 v85, v85, v98
    v_sub_f32 v86, v86, v98
    v_sub_f32 v87, v87, v98
    v_sub_f32 v92, v92, v98
    v_sub_f32 v93, v93, v98
    v_sub_f32 v94, v94, v98
    v_sub_f32 v95, v95, v98
    v_exp_f32 v80, v80
    v_exp_f32 v81, v81
    v_exp_f32 v82, v82
    v_exp_f32 v83, v83
    v_exp_f32 v88, v88
    v_exp_f32 v89, v89
    v_exp_f32 v90, v90
    v_exp_f32 v91, v91
    v_exp_f32 v84, v84
    v_exp_f32 v85, v85
    v_exp_f32 v86, v86
    v_exp_f32 v87, v87
    v_exp_f32 v92, v92
    v_exp_f32 v93, v93
    v_exp_f32 v94, v94
    v_exp_f32 v95, v95
    s_nop 0
    v_add_f32 v100, v80, v81
    v_add_f32 v112, v82, v83
    v_add_f32 v113, v88, v89
    v_add_f32 v114, v90, v91
    v_add_f32 v100, v100, v112
    v_add_f32 v113, v113, v114
    v_add_f32 v100, v100, v113
    v_cvt_pk_bf16_f32 v104, v80, v81
    v_cvt_pk_bf16_f32 v105, v82, v83
    v_cvt_pk_bf16_f32 v106, v88, v89
    v_cvt_pk_bf16_f32 v107, v90, v91
    ds_write_b128 v10, v[104:107] offset:0
    v_add_f32 v101, v84, v85
    v_add_f32 v112, v86, v87
    v_add_f32 v113, v92, v93
    v_add_f32 v114, v94, v95
    v_add_f32 v101, v101, v112
    v_add_f32 v113, v113, v114
    v_add_f32 v101, v101, v113
    v_cvt_pk_bf16_f32 v108, v84, v85
    v_cvt_pk_bf16_f32 v109, v86, v87
    v_cvt_pk_bf16_f32 v110, v92, v93
    v_cvt_pk_bf16_f32 v111, v94, v95
    ds_write_b128 v10, v[108:111] offset:1024
    v_add_f32 v100, v100, v101
    ds_write_b32 v8, v100 offset:4608
    s_lshl_b32 s60, s51, 13
    s_add_u32 s59, s64, 0
    s_add_u32 m0, s60, 65536
    s_nop 0
    buffer_load_dwordx4 v5, s[28:31], s59 offen nt lds
    s_add_u32 s59, s64, 0
    s_add_u32 m0, s60, 66560
    s_nop 0
    buffer_load_dwordx4 v6, s[28:31], s59 offen nt lds
    s_add_u32 s59, s64, 16384
    s_add_u32 m0, s60, 67584
    s_nop 0
    buffer_load_dwordx4 v5, s[28:31], s59 offen nt lds
    s_add_u32 s59, s64, 16384
    s_add_u32 m0, s60, 68608
    s_nop 0
    buffer_load_dwordx4 v6, s[28:31], s59 offen nt lds
    s_add_u32 s59, s65, 0
    s_add_u32 m0, s60, 69632
    s_nop 0
    buffer_load_dwordx4 v5, s[28:31], s59 offen nt lds
    s_add_u32 s59, s65, 0
    s_add_u32 m0, s60, 70656
    s_nop 0
    buffer_load_dwordx4 v6, s[28:31], s59 offen nt lds
    s_add_u32 s59, s65, 16384
    s_add_u32 m0, s60, 71680
    s_nop 0
    buffer_load_dwordx4 v5, s[28:31], s59 offen nt lds
    s_add_u32 s59, s65, 16384
    s_add_u32 m0, s60, 72704
    s_nop 0
    buffer_load_dwordx4 v6, s[28:31], s59 offen nt lds
L_sumw_F:
    ds_write_b32 v8, v100 offset:4608
    s_waitcnt lgkmcnt(0)
    s_barrier
    v_lshlrev_b32 v104, 4, v1
    v_add_u32 v104, 131072, v104
    ds_read_b128 v[144:147], v104 offset:0
    ds_read_b128 v[148:151], v104 offset:1024
    ds_read_b128 v[152:155], v104 offset:2048
    ds_read_b128 v[156:159], v104 offset:3072
    ds_read_b128 v[160:163], v104 offset:4096
    ds_read_b128 v[164:167], v104 offset:5120
    ds_read_b128 v[168:171], v104 offset:6144
    ds_read_b128 v[172:175], v104 offset:7168
    ds_read_b128 v[176:179], v104 offset:8192
    ds_read_b128 v[180:183], v104 offset:9216
    ds_read_b128 v[184:187], v104 offset:10240
    ds_read_b128 v[188:191], v104 offset:11264
    ds_read_b128 v[192:195], v104 offset:12288
    ds_read_b128 v[196:199], v104 offset:13312
    ds_read_b128 v[200:203], v104 offset:14336
    ds_read_b128 v[204:207], v104 offset:15360
    v_mov_b32 v80, 0
    v_mov_b32 v81, 0
    v_mov_b32 v82, 0
    v_mov_b32 v83, 0
    v_mov_b32 v47, 0xff800000
    ds_read_b128 v[112:115], v9 offset:4608
    ds_read_b128 v[116:119], v9 offset:4624
    ds_read_b128 v[120:123], v9 offset:4640
    ds_read_b128 v[124:127], v9 offset:4656
    ds_read_b128 v[128:131], v9 offset:4672
    ds_read_b128 v[132:135], v9 offset:4688
    ds_read_b128 v[136:139], v9 offset:4704
    ds_read_b128 v[140:143], v9 offset:4720
    s_waitcnt lgkmcnt(0)
    v_add_f32 v112, v112, v113
    v_add_f32 v114, v114, v115
    v_add_f32 v116, v116, v117
    v_add_f32 v118, v118, v119
    v_add_f32 v120, v120, v121
    v_add_f32 v122, v122, v123
    v_add_f32 v124, v124, v125
    v_add_f32 v126, v126, v127
    v_add_f32 v128, v128, v129
    v_add_f32 v130, v130, v131
    v_add_f32 v132, v132, v133
    v_add_f32 v134, v134, v135
    v_add_f32 v136, v136, v137
    v_add_f32 v138, v138, v139
    v_add_f32 v140, v140, v141
    v_add_f32 v142, v142, v143
    v_add_f32 v112, v112, v114
    v_add_f32 v116, v116, v118
    v_add_f32 v120, v120, v122
    v_add_f32 v124, v124, v126
    v_add_f32 v128, v128, v130
    v_add_f32 v132, v132, v134
    v_add_f32 v136, v136, v138
    v_add_f32 v140, v140, v142
    v_add_f32 v112, v112, v116
    v_add_f32 v120, v120, v124
    v_add_f32 v128, v128, v132
    v_add_f32 v136, v136, v140
    v_add_f32 v112, v112, v120
    v_add_f32 v128, v128, v136
    v_add_f32 v112, v112, v128
    v_cndmask_b32 v74, v47, v98, s[4:5]
    v_cndmask_b32 v75, 0, v112, s[4:5]
    s_mov_b32 s56, 0x0
    s_mov_b32 s57, 0x1000000
    s_cmp_eq_u32 s97, 31
    s_cselect_b32 s56, 0x1000000, s56
    s_cselect_b32 s57, 0x1010101, s57
    s_or_b32 s25, s25, s56
    s_or_b32 s26, s26, s57
    s_and_b32 s98, s20, 0x01010101
    s_and_b32 s98, s98, s21
    s_and_b32 s98, s98, s22
    s_and_b32 s98, s98, s23
    s_and_b32 s98, s98, s24
    s_and_b32 s98, s98, s25
    s_and_b32 s98, s98, s26
    s_cmp_eq_u32 s98, 0x01010101
    s_cselect_b32 s98, 1, 0
    s_cmp_lt_i32 s51, s101
    s_cbranch_scc1 L_f3
    s_waitcnt vmcnt(0)
L_f3:
    s_waitcnt vmcnt(8)
    s_barrier
    buffer_load_dwordx2 v[32:33], v68, s[44:47], 0 offen sc1
    buffer_load_dwordx4 v[16:19], v64, s[44:47], 0 offen sc1
    buffer_load_dwordx2 v[34:35], v69, s[44:47], 0 offen sc1
    buffer_load_dwordx4 v[20:23], v65, s[44:47], 0 offen sc1
    buffer_load_dwordx2 v[36:37], v70, s[44:47], 0 offen sc1
    buffer_load_dwordx4 v[24:27], v66, s[44:47], 0 offen sc1
    buffer_load_dwordx2 v[38:39], v71, s[44:47], 0 offen sc1
    buffer_load_dwordx4 v[28:31], v67, s[44:47], 0 offen sc1
    s_cmp_eq_u32 s52, 0
    s_cbranch_scc1 L_f6
    s_cmp_le_i32 s52, 1
    s_cbranch_scc1 L_pr1_Fa
    s_cmp_le_i32 s52, 2
    s_cbranch_scc1 L_pr2_Fa
    s_cmp_le_i32 s52, 3
    s_cbranch_scc1 L_pr3_Fa
    s_cmp_le_i32 s52, 4
    s_cbranch_scc1 L_pr4_Fa
    s_cmp_le_i32 s52, 5
    s_cbranch_scc1 L_pr5_Fa
    s_cmp_le_i32 s52, 6
    s_cbranch_scc1 L_pr6_Fa
    s_cmp_le_i32 s52, 7
    s_cbranch_scc1 L_pr7_Fa
L_pr8_Fa:
    ds_read_b64_tr_b16 v[236:237], v11 offset:57344
    ds_read_b64_tr_b16 v[238:239], v11 offset:61440
L_pr7_Fa:
    ds_read_b64_tr_b16 v[232:233], v11 offset:49152
    ds_read_b64_tr_b16 v[234:235], v11 offset:53248
L_pr6_Fa:
    ds_read_b64_tr_b16 v[228:229], v11 offset:40960
    ds_read_b64_tr_b16 v[230:231], v11 offset:45056
L_pr5_Fa:
    ds_read_b64_tr_b16 v[224:225], v11 offset:32768
    ds_read_b64_tr_b16 v[226:227], v11 offset:36864
L_pr4_Fa:
    ds_read_b64_tr_b16 v[220:221], v11 offset:24576
    ds_read_b64_tr_b16 v[222:223], v11 offset:28672
L_pr3_Fa:
    ds_read_b64_tr_b16 v[216:217], v11 offset:16384
    ds_read_b64_tr_b16 v[218:219], v11 offset:20480
L_pr2_Fa:
    ds_read_b64_tr_b16 v[212:213], v11 offset:8192
    ds_read_b64_tr_b16 v[214:215], v11 offset:12288
L_pr1_Fa:
    ds_read_b64_tr_b16 v[208:209], v11 offset:0
    ds_read_b64_tr_b16 v[210:211], v11 offset:4096
    s_cmp_le_i32 s52, 1
    s_cbranch_scc1 L_pm1_Fa
    s_cmp_le_i32 s52, 2
    s_cbranch_scc1 L_pm2_Fa
    s_cmp_le_i32 s52, 3
    s_cbranch_scc1 L_pm3_Fa
    s_cmp_le_i32 s52, 4
    s_cbranch_scc1 L_pm4_Fa
    s_cmp_le_i32 s52, 5
    s_cbranch_scc1 L_pm5_Fa
    s_cmp_le_i32 s52, 6
    s_cbranch_scc1 L_pm6_Fa
    s_cmp_le_i32 s52, 7
    s_cbranch_scc1 L_pm7_Fa
L_pm8_Fa:
    s_waitcnt lgkmcnt(14)
    v_mfma_f32_16x16x32_bf16 v[80:83], v[236:239], v[200:203], v[80:83]
L_pm7_Fa:
    s_waitcnt lgkmcnt(12)
    v_mfma_f32_16x16x32_bf16 v[80:83], v[232:235], v[192:195], v[80:83]
L_pm6_Fa:
    s_waitcnt lgkmcnt(10)
    v_mfma_f32_16x16x32_bf16 v[80:83], v[228:231], v[184:187], v[80:83]
L_pm5_Fa:
    s_waitcnt lgkmcnt(8)
    v_mfma_f32_16x16x32_bf16 v[80:83], v[224:227], v[176:179], v[80:83]
L_pm4_Fa:
    s_waitcnt lgkmcnt(6)
    v_mfma_f32_16x16x32_bf16 v[80:83], v[220:223], v[168:171], v[80:83]
L_pm3_Fa:
    s_waitcnt lgkmcnt(4)
    v_mfma_f32_16x16x32_bf16 v[80:83], v[216:219], v[160:163], v[80:83]
L_pm2_Fa:
    s_waitcnt lgkmcnt(2)
    v_mfma_f32_16x16x32_bf16 v[80:83], v[212:215], v[152:155], v[80:83]
L_pm1_Fa:
    s_waitcnt lgkmcnt(0)
    v_mfma_f32_16x16x32_bf16 v[80:83], v[208:211], v[144:147], v[80:83]
    s_cmp_le_i32 s101, 0
    s_cbranch_scc1 L_f6
    s_cmp_ge_i32 s101, 8
    s_cbranch_scc1 L_pb8_Fb
    s_cmp_ge_i32 s101, 7
    s_cbranch_scc1 L_pb7_Fb
    s_cmp_ge_i32 s101, 6
    s_cbranch_scc1 L_pb6_Fb
    s_cmp_ge_i32 s101, 5
    s_cbranch_scc1 L_pb5_Fb
    s_cmp_ge_i32 s101, 4
    s_cbranch_scc1 L_pb4_Fb
    s_cmp_ge_i32 s101, 3
    s_cbranch_scc1 L_pb3_Fb
    s_cmp_ge_i32 s101, 2
    s_cbranch_scc1 L_pb2_Fb
L_pb1_Fb:
    s_waitcnt vmcnt(8)
    s_barrier
    s_branch L_pr1_Fb
L_pb2_Fb:
    s_waitcnt vmcnt(8)
    s_barrier
    s_branch L_pr2_Fb
L_pb3_Fb:
    s_waitcnt vmcnt(8)
    s_barrier
    s_branch L_pr3_Fb
L_pb4_Fb:
    s_waitcnt vmcnt(8)
    s_barrier
    s_branch L_pr4_Fb
L_pb5_Fb:
    s_waitcnt vmcnt(8)
    s_barrier
    s_branch L_pr5_Fb
L_pb6_Fb:
    s_waitcnt vmcnt(8)
    s_barrier
    s_branch L_pr6_Fb
L_pb7_Fb:
    s_waitcnt vmcnt(8)
    s_barrier
    s_branch L_pr7_Fb
L_pb8_Fb:
    s_waitcnt vmcnt(8)
    s_barrier
L_pr8_Fb:
    ds_read_b64_tr_b16 v[236:237], v251 offset:57344
    ds_read_b64_tr_b16 v[238:239], v251 offset:61440
L_pr7_Fb:
    ds_read_b64_tr_b16 v[232:233], v251 offset:49152
    ds_read_b64_tr_b16 v[234:235], v251 offset:53248
L_pr6_Fb:
    ds_read_b64_tr_b16 v[228:229], v251 offset:40960
    ds_read_b64_tr_b16 v[230:231], v251 offset:45056
L_pr5_Fb:
    ds_read_b64_tr_b16 v[224:225], v251 offset:32768
    ds_read_b64_tr_b16 v[226:227], v251 offset:36864
L_pr4_Fb:
    ds_read_b64_tr_b16 v[220:221], v251 offset:24576
    ds_read_b64_tr_b16 v[222:223], v251 offset:28672
L_pr3_Fb:
    ds_read_b64_tr_b16 v[216:217], v251 offset:16384
    ds_read_b64_tr_b16 v[218:219], v251 offset:20480
L_pr2_Fb:
    ds_read_b64_tr_b16 v[212:213], v251 offset:8192
    ds_read_b64_tr_b16 v[214:215], v251 offset:12288
L_pr1_Fb:
    ds_read_b64_tr_b16 v[208:209], v251 offset:0
    ds_read_b64_tr_b16 v[210:211], v251 offset:4096
    s_cmp_le_i32 s101, 1
    s_cbranch_scc1 L_pm1_Fb
    s_cmp_le_i32 s101, 2
    s_cbranch_scc1 L_pm2_Fb
    s_cmp_le_i32 s101, 3
    s_cbranch_scc1 L_pm3_Fb
    s_cmp_le_i32 s101, 4
    s_cbranch_scc1 L_pm4_Fb
    s_cmp_le_i32 s101, 5
    s_cbranch_scc1 L_pm5_Fb
    s_cmp_le_i32 s101, 6
    s_cbranch_scc1 L_pm6_Fb
    s_cmp_le_i32 s101, 7
    s_cbranch_scc1 L_pm7_Fb
L_pm8_Fb:
    s_waitcnt lgkmcnt(14)
    v_mfma_f32_16x16x32_bf16 v[80:83], v[236:239], v[204:207], v[80:83]
L_pm7_Fb:
    s_waitcnt lgkmcnt(12)
    v_mfma_f32_16x16x32_bf16 v[80:83], v[232:235], v[196:199], v[80:83]
L_pm6_Fb:
    s_waitcnt lgkmcnt(10)
    v_mfma_f32_16x16x32_bf16 v[80:83], v[228:231], v[188:191], v[80:83]
L_pm5_Fb:
    s_waitcnt lgkmcnt(8)
    v_mfma_f32_16x16x32_bf16 v[80:83], v[224:227], v[180:183], v[80:83]
L_pm4_Fb:
    s_waitcnt lgkmcnt(6)
    v_mfma_f32_16x16x32_bf16 v[80:83], v[220:223], v[172:175], v[80:83]
L_pm3_Fb:
    s_waitcnt lgkmcnt(4)
    v_mfma_f32_16x16x32_bf16 v[80:83], v[216:219], v[164:167], v[80:83]
L_pm2_Fb:
    s_waitcnt lgkmcnt(2)
    v_mfma_f32_16x16x32_bf16 v[80:83], v[212:215], v[156:159], v[80:83]
L_pm1_Fb:
    s_waitcnt lgkmcnt(0)
    v_mfma_f32_16x16x32_bf16 v[80:83], v[208:211], v[148:151], v[80:83]
L_f6:
    s_mov_b32 s99, 0
    s_cmp_lg_u32 s98, 0
    s_cbranch_scc1 L_chk
    s_sub_u32 s56, s97, 8
    v_and_b32 v112, 7, v1
    v_lshlrev_b32 v112, 2, v112
    v_sub_u32 v112, s56, v112
    v_min_i32 v112, 4, v112
    v_cmp_lt_i32 vcc, 0, v112
    v_lshlrev_b32 v112, 3, v112
    v_sub_u32 v112, 32, v112
    v_mov_b32 v113, 0x01010101
    v_lshrrev_b32 v112, v112, v113
    v_cndmask_b32 v240, 0, v112, vcc
    v_lshrrev_b32 v112, 3, v1
    v_cmp_eq_u32 vcc, s48, v112
    s_nop 1
    v_cndmask_b32 v240, 0, v240, vcc
L_pl:
    buffer_load_dword v73, v253, s[40:43], 0 offen sc1
    s_waitcnt vmcnt(0)
    v_and_b32 v73, v73, v240
    v_cmp_ne_u32 vcc, v73, v240
    s_add_u32 s99, s99, 1
    s_cbranch_vccz L_pl2
    s_cmp_lt_u32 s99, 1048576
    s_cbranch_scc1 L_pl
L_pl2:
    buffer_load_dwordx2 v[32:33], v68, s[44:47], 0 offen sc1
    buffer_load_dwordx4 v[16:19], v64, s[44:47], 0 offen sc1
    buffer_load_dwordx2 v[34:35], v69, s[44:47], 0 offen sc1
    buffer_load_dwordx4 v[20:23], v65, s[44:47], 0 offen sc1
    buffer_load_dwordx2 v[36:37], v70, s[44:47], 0 offen sc1
    buffer_load_dwordx4 v[24:27], v66, s[44:47], 0 offen sc1
    buffer_load_dwordx2 v[38:39], v71, s[44:47], 0 offen sc1
    buffer_load_dwordx4 v[28:31], v67, s[44:47], 0 offen sc1
L_chk:
    s_waitcnt vmcnt(0)
    v_max3_u32 v40, v16, v17, v18
    v_max3_u32 v40, v40, v19, v32
    v_max_u32 v40, v40, v33
    v_max3_u32 v41, v20, v21, v22
    v_max3_u32 v41, v41, v23, v34
    v_max_u32 v41, v41, v35
    v_max3_u32 v42, v24, v25, v26
    v_max3_u32 v42, v42, v27, v36
    v_max_u32 v42, v42, v37
    v_max3_u32 v43, v28, v29, v30
    v_max3_u32 v43, v43, v31, v38
    v_max_u32 v43, v43, v39
    v_max3_u32 v44, v40, v41, v42
    v_max_u32 v44, v44, v43
    v_cmp_eq_u32 vcc, -1, v44
    s_add_u32 s99, s99, 1
    s_cbranch_vccz L_comb
    s_cmp_ge_u32 s99, 1048576
    s_cbranch_scc1 L_comb
    v_cmp_eq_u32 s[56:57], -1, v40
    v_cmp_eq_u32 s[58:59], -1, v41
    v_cmp_eq_u32 s[60:61], -1, v42
    v_cmp_eq_u32 s[62:63], -1, v43
    s_nop 3
    s_mov_b64 exec, s[56:57]
    buffer_load_dwordx2 v[32:33], v68, s[44:47], 0 offen sc1
    buffer_load_dwordx4 v[16:19], v64, s[44:47], 0 offen sc1
    s_mov_b64 exec, s[58:59]
    buffer_load_dwordx2 v[34:35], v69, s[44:47], 0 offen sc1
    buffer_load_dwordx4 v[20:23], v65, s[44:47], 0 offen sc1
    s_mov_b64 exec, s[60:61]
    buffer_load_dwordx2 v[36:37], v70, s[44:47], 0 offen sc1
    buffer_load_dwordx4 v[24:27], v66, s[44:47], 0 offen sc1
    s_mov_b64 exec, s[62:63]
    buffer_load_dwordx2 v[38:39], v71, s[44:47], 0 offen sc1
    buffer_load_dwordx4 v[28:31], v67, s[44:47], 0 offen sc1
    s_mov_b64 exec, -1
    s_branch L_chk
L_comb:
    v_cndmask_b32 v34, v47, v34, s[14:15]
    v_cndmask_b32 v36, v47, v36, s[16:17]
    v_cndmask_b32 v38, v47, v38, s[18:19]
    v_max3_f32 v112, v32, v34, v36
    v_max3_f32 v112, v112, v38, v74
    v_cndmask_b32 v80, 0, v80, s[4:5]
    v_cndmask_b32 v81, 0, v81, s[4:5]
    v_max_f32_dpp v112, v112, v112 row_ror:4 row_mask:0xf bank_mask:0xf
    v_cndmask_b32 v82, 0, v82, s[4:5]
    v_cndmask_b32 v83, 0, v83, s[4:5]
    v_max_f32_dpp v112, v112, v112 row_ror:8 row_mask:0xf bank_mask:0xf
    v_sub_f32 v40, v32, v112
    v_sub_f32 v41, v34, v112
    v_sub_f32 v42, v36, v112
    v_sub_f32 v43, v38, v112
    v_sub_f32 v44, v74, v112
    v_exp_f32 v40, v40
    v_exp_f32 v41, v41
    v_exp_f32 v42, v42
    v_exp_f32 v43, v43
    v_exp_f32 v44, v44
    s_nop 0
    v_mul_f32 v113, v44, v75
    v_fmac_f32 v113, v40, v33
    v_fmac_f32 v113, v41, v35
    v_fmac_f32 v113, v42, v37
    v_fmac_f32 v113, v43, v39
    v_mul_f32 v80, v44, v80
    v_mul_f32 v81, v44, v81
    v_mul_f32 v82, v44, v82
    v_mul_f32 v83, v44, v83
    v_add_f32_dpp v113, v113, v113 row_ror:4 row_mask:0xf bank_mask:0xf
    v_fmac_f32 v80, v40, v16
    v_fmac_f32 v81, v40, v17
    v_fmac_f32 v82, v40, v18
    v_fmac_f32 v83, v40, v19
    v_add_f32_dpp v113, v113, v113 row_ror:8 row_mask:0xf bank_mask:0xf
    v_fmac_f32 v80, v41, v20
    v_fmac_f32 v81, v41, v21
    v_fmac_f32 v82, v41, v22
    v_fmac_f32 v83, v41, v23
    v_rcp_f32 v114, v113
    v_fmac_f32 v80, v42, v24
    v_fmac_f32 v81, v42, v25
    v_fmac_f32 v82, v42, v26
    v_fmac_f32 v83, v42, v27
    v_fma_f32 v115, -v113, v114, 1.0
    v_fmac_f32 v114, v115, v114
    v_fmac_f32 v80, v43, v28
    v_fmac_f32 v81, v43, v29
    v_fmac_f32 v82, v43, v30
    v_fmac_f32 v83, v43, v31
    v_add_f32_dpp v80, v80, v80 row_ror:4 row_mask:0xf bank_mask:0xf
    v_add_f32_dpp v81, v81, v81 row_ror:4 row_mask:0xf bank_mask:0xf
    v_add_f32_dpp v82, v82, v82 row_ror:4 row_mask:0xf bank_mask:0xf
    v_add_f32_dpp v83, v83, v83 row_ror:4 row_mask:0xf bank_mask:0xf
    v_add_f32_dpp v80, v80, v80 row_ror:8 row_mask:0xf bank_mask:0xf
    v_add_f32_dpp v81, v81, v81 row_ror:8 row_mask:0xf bank_mask:0xf
    v_add_f32_dpp v82, v82, v82 row_ror:8 row_mask:0xf bank_mask:0xf
    v_add_f32_dpp v83, v83, v83 row_ror:8 row_mask:0xf bank_mask:0xf
    v_mul_f32 v80, v80, v114
    v_mul_f32 v81, v81, v114
    v_mul_f32 v82, v82, v114
    v_mul_f32 v83, v83, v114
    v_cvt_pk_bf16_f32 v84, v80, v81
    v_cvt_pk_bf16_f32 v85, v82, v83
    s_mov_b32 exec_lo, 0x000f000f
    s_mov_b32 exec_hi, 0x000f000f
    buffer_store_dwordx2 v[84:85], v72, s[36:39], 0 offen
    s_mov_b64 exec, -1
    s_branch L_fin
L_item:
    s_cmp_lt_u32 s49, s16
    s_cselect_b32 s56, 0, 256
    buffer_load_dwordx2 v[240:241], v252, s[32:35], s56 offen offset:0
    buffer_load_dwordx2 v[242:243], v252, s[32:35], s56 offen offset:1024
    buffer_load_dwordx2 v[244:245], v252, s[32:35], s56 offen offset:2048
    buffer_load_dwordx2 v[246:247], v252, s[32:35], s56 offen offset:3072
    s_sub_u32 s56, s49, s16
    s_add_u32 s57, s56, 16
    s_add_u32 s56, s56, 8
    s_sub_u32 s59, s49, 8
    s_lshl_b32 s58, s59, 1
    s_cmp_lt_u32 s49, s16
    s_cselect_b32 s57, s58, s57
    s_cselect_b32 s56, s59, s56
    s_lshl_b32 s57, s57, 13
    s_lshl_b32 s56, s56, 8
    s_mul_i32 s58, s48, 393216
    s_add_u32 s12, s57, s58
    s_mul_i32 s58, s48, 10240
    s_add_u32 s56, s56, s58
    s_add_u32 s13, s56, 3145728
    s_waitcnt vmcnt(0)
    s_branch L_item2
L_st1:
    s_branch L_bk
L_item2:
    s_sub_u32 s58, s49, 8
    s_cmp_lt_u32 s58, s1
    s_addc_u32 s52, s0, 0
    s_min_u32 s56, s58, s1
    s_mul_i32 s57, s58, s0
    s_add_u32 s88, s56, s57
    v_lshrrev_b32 v112, 3, v254
    v_subrev_u32 v112, s88, v112
    v_cmp_gt_u32 s[94:95], s52, v112
    s_add_u32 s6, s88, s51
    s_lshl_b32 s53, s6, 1
    s_sub_u32 s99, s49, s16
    s_cmp_ge_u32 s49, s16
    s_cbranch_scc1 L_ptype
    s_waitcnt vmcnt(12)
    s_cmp_eq_u32 s54, 1
    s_cbranch_scc1 L_sw_W
    s_waitcnt vmcnt(4)
L_sw_W:
    v_readlane_b32 s82, v248, s6
    v_readlane_b32 s83, v249, s6
    v_cmp_ne_u32 vcc, v240, v248
    v_cmp_ne_u32 s[62:63], v241, v249
    s_or_b64 vcc, vcc, s[62:63]
    v_cmp_ne_u32 s[62:63], v242, v248
    s_or_b64 vcc, vcc, s[62:63]
    v_cmp_ne_u32 s[62:63], v243, v249
    s_or_b64 vcc, vcc, s[62:63]
    v_cmp_ne_u32 s[62:63], v244, v248
    s_or_b64 vcc, vcc, s[62:63]
    v_cmp_ne_u32 s[62:63], v245, v249
    s_or_b64 vcc, vcc, s[62:63]
    v_cmp_ne_u32 s[62:63], v246, v248
    s_or_b64 vcc, vcc, s[62:63]
    v_cmp_ne_u32 s[62:63], v247, v249
    s_or_b64 vcc, vcc, s[62:63]
    s_and_b64 vcc, vcc, s[94:95]
    s_lshl_b32 s82, s82, 15
    s_lshl_b32 s83, s83, 15
    s_cbranch_vccnz L_fallback
    s_cmp_eq_u32 s54, 0
    s_cbranch_scc1 L_norm_W
    s_mov_b32 s54, 0
    s_lshl_b32 s56, s51, 13
    s_cmp_lg_u32 s56, s80
    s_cbranch_scc1 L_mis_W
    s_cmp_ge_u32 s51, s52
    s_cbranch_scc1 L_nok_W
    s_cmp_eq_u64 s[82:83], s[78:79]
    s_cbranch_scc1 L_nok_W
    s_cmp_eq_u32 s78, -1
    s_cbranch_scc1 L_noq_W
L_mis_W:
    s_waitcnt vmcnt(0)
L_norm_W:
    s_and_b32 s56, s51, 3
    s_lshl_b32 s56, s56, 2
    v_add_u32 v142, s56, v2
    v_xor_b32 v142, v142, v3
    v_lshl_add_u32 v142, v142, 4, v15
    s_lshl_b32 s56, s51, 13
    s_lshl_b32 s57, s51, 10
    s_add_u32 m0, s57, 131072
    s_nop 0
    buffer_load_dwordx4 v142, s[20:23], s56 offen lds
L_noq_W:
    s_cmp_ge_u32 s51, s52
    s_cbranch_scc1 L_nok_W
    s_lshl_b32 s60, s51, 13
    s_add_u32 m0, s60, 0
    s_nop 0
    buffer_load_dwordx4 v4, s[24:27], s82 offen nt lds
    s_add_u32 m0, s60, 1024
    s_nop 0
    buffer_load_dwordx4 v7, s[24:27], s82 offen nt lds
    s_add_u32 m0, s60, 2048
    s_nop 0
    buffer_load_dwordx4 v12, s[24:27], s82 offen nt lds
    s_add_u32 m0, s60, 3072
    s_nop 0
    buffer_load_dwordx4 v0, s[24:27], s82 offen nt lds
    s_add_u32 m0, s60, 4096
    s_nop 0
    buffer_load_dwordx4 v4, s[24:27], s83 offen nt lds
    s_add_u32 m0, s60, 5120
    s_nop 0
    buffer_load_dwordx4 v7, s[24:27], s83 offen nt lds
    s_add_u32 m0, s60, 6144
    s_nop 0
    buffer_load_dwordx4 v12, s[24:27], s83 offen nt lds
    s_add_u32 m0, s60, 7168
    s_nop 0
    buffer_load_dwordx4 v0, s[24:27], s83 offen nt lds
L_nok_W:
    v_add_u32 v131, 15, v250
    v_add_u32 v132, -1, v250
    v_cmp_gt_u32 vcc, 0x800, v132
    v_lshrrev_b32 v131, 4, v131
    v_mov_b32 v128, 0x80
    s_nop 0
    v_cndmask_b32 v128, v128, v131, vcc
    v_subrev_u32 v131, 63, v128
    v_max_i32 v131, 0, v131
    v_lshrrev_b32 v126, 1, v131
    v_subrev_u32 v131, s15, v126
    v_max_i32 v131, 0, v131
    v_cndmask_b32 v129, 0, v131, s[92:93]
    v_cndmask_b32 v130, 0, v131, s[92:93]
    v_cmp_gt_u32 s[58:59], 3, v131
    s_nop 0
    v_add_u32_dpp v130, v130, v130 row_shr:1 row_mask:0xf bank_mask:0xf bound_ctrl:0
    s_nop 1
    v_add_u32_dpp v130, v130, v130 row_shr:2 row_mask:0xf bank_mask:0xf bound_ctrl:0
    s_nop 1
    v_add_u32_dpp v130, v130, v130 row_shr:4 row_mask:0xf bank_mask:0xf bound_ctrl:0
    s_nop 1
    v_readlane_b32 s7, v130, 3
    v_readlane_b32 s8, v130, 7
    v_cmp_lt_u32 vcc, 3, v1
    s_nop 2
    s_and_b32 s58, s58, 0x7e
    s_cselect_b32 s57, s7, 0
    s_cselect_b32 s7, s7, s8
    s_cselect_b32 s11, 15, 0xff
    s_sub_u32 s8, s8, s7
    v_mov_b32 v131, s57
    v_cndmask_b32 v131, 0, v131, vcc
    v_add3_u32 v132, s7, v1, 3
    v_add3_u32 v135, s8, v1, 3
    v_mul_u32_u24 v132, v132, v255
    v_mul_u32_u24 v135, v135, v255
    v_lshrrev_b32 v132, 18, v132
    v_lshrrev_b32 v135, 18, v135
    v_add_u32 v135, v135, v132
    v_cmp_ge_u32 vcc, s96, v135
    v_sub_u32 v134, v130, v131
    v_sub_u32 v133, v134, v129
    s_or_b32 s56, vcc_lo, 16
    s_ff1_i32_b32 s56, s56
    v_readlane_b32 s10, v132, s56
    v_readlane_b32 s55, v135, s56
    v_readlane_b32 s100, v255, s56
    s_add_u32 s9, s56, 4
    s_nop 2
    s_add_u32 s55, s55, s16
    s_add_u32 s56, s17, s97
    s_sub_u32 s56, s56, 8
    s_cmp_ge_u32 s56, s55
    s_cbranch_scc1 L_no2_W
    s_cmp_lg_u32 s14, s51
    s_cbranch_scc1 L_no2_W
    s_sub_u32 s56, s56, s16
    s_add_u32 s57, s56, 16
    s_lshl_b32 s57, s57, 13
    s_mul_i32 s58, s48, 393216
    s_add_u32 s57, s57, s58
    s_add_u32 s56, s56, 8
    s_lshl_b32 s56, s56, 8
    s_mul_i32 s58, s48, 10240
    s_add_u32 s56, s56, s58
    s_add_u32 s56, s56, 3145728
    v_mov_b32 v144, -1
    v_mov_b32 v145, -1
    v_mov_b32 v146, -1
    v_mov_b32 v147, -1
    buffer_store_dwordx4 v[144:147], v13, s[44:47], s57 offen sc1
    s_mov_b64 exec, 0xffff
    buffer_store_dwordx2 v[144:145], v254, s[44:47], s56 offen sc1
    s_mov_b64 exec, -1
    s_waitcnt vmcnt(0)
L_no2_W:
    s_cmp_ge_u32 s51, s52
    s_cbranch_scc1 L_idle1_W
    s_lshl_b32 s57, s53, 4
    v_lshl_add_u32 v143, v2, 2, s57
    v_and_b32 v140, 12, v3
    v_add_u32 v141, 16, v140
    ds_bpermute_b32 v96, v140, v250
    ds_bpermute_b32 v97, v141, v250
    v_mov_b32 v14, 0xceabfb8f
    s_lshl_b32 s57, s51, 13
    v_add_u32 v136, 0, v2
    v_xor_b32 v136, v136, v3
    v_lshlrev_b32 v136, 4, v136
    v_lshl_add_u32 v136, v3, 8, v136
    v_add_u32 v120, s57, v136
    v_add_u32 v136, 131072, v136
    v_add_u32 v137, 4, v2
    v_xor_b32 v137, v137, v3
    v_lshlrev_b32 v137, 4, v137
    v_lshl_add_u32 v137, v3, 8, v137
    v_add_u32 v121, s57, v137
    v_add_u32 v137, 131072, v137
    v_add_u32 v138, 8, v2
    v_xor_b32 v138, v138, v3
    v_lshlrev_b32 v138, 4, v138
    v_lshl_add_u32 v138, v3, 8, v138
    v_add_u32 v122, s57, v138
    v_add_u32 v138, 131072, v138
    v_add_u32 v139, 12, v2
    v_xor_b32 v139, v139, v3
    v_lshlrev_b32 v139, 4, v139
    v_lshl_add_u32 v139, v3, 8, v139
    v_add_u32 v123, s57, v139
    v_add_u32 v139, 131072, v139
    s_waitcnt vmcnt(8)
    s_barrier
    s_cmp_lg_u32 s14, 7
    s_cbranch_scc1 L_nosig_Wa
    v_mov_b32 v102, 1
    s_mov_b64 exec, 1
    s_lshl_b32 s56, s48, 5
    s_add_u32 s56, s56, s17
    s_sub_u32 s56, s56, 8
    buffer_store_byte v102, off, s[40:43], s56 sc1
    s_mov_b64 exec, -1
L_nosig_Wa:
    ds_read_b128 v[48:51], v136 offset:0
    ds_read_b128 v[52:55], v137 offset:0
    ds_read_b128 v[56:59], v138 offset:0
    ds_read_b128 v[60:63], v139 offset:0
    ds_read_b128 v[64:67], v136 offset:4096
    ds_read_b128 v[68:71], v137 offset:4096
    ds_read_b128 v[72:75], v138 offset:4096
    ds_read_b128 v[76:79], v139 offset:4096
    s_lshl_b32 s60, s51, 13
    s_lshl_b32 s60, s51, 13
    s_add_u32 s59, s82, 0
    s_add_u32 m0, s60, 65536
    s_waitcnt vmcnt(7)
    buffer_load_dwordx4 v5, s[28:31], s59 offen nt lds
    s_add_u32 s59, s82, 0
    s_add_u32 m0, s60, 66560
    s_waitcnt vmcnt(7)
    buffer_load_dwordx4 v6, s[28:31], s59 offen nt lds
    s_add_u32 s59, s82, 16384
    s_add_u32 m0, s60, 67584
    s_waitcnt vmcnt(7)
    buffer_load_dwordx4 v5, s[28:31], s59 offen nt lds
    s_add_u32 s59, s82, 16384
    s_add_u32 m0, s60, 68608
    s_waitcnt vmcnt(7)
    buffer_load_dwordx4 v6, s[28:31], s59 offen nt lds
    s_add_u32 s59, s83, 0
    s_add_u32 m0, s60, 69632
    s_waitcnt vmcnt(7)
    buffer_load_dwordx4 v5, s[28:31], s59 offen nt lds
    s_add_u32 s59, s83, 0
    s_add_u32 m0, s60, 70656
    s_waitcnt vmcnt(7)
    buffer_load_dwordx4 v6, s[28:31], s59 offen nt lds
    s_add_u32 s59, s83, 16384
    s_add_u32 m0, s60, 71680
    s_waitcnt vmcnt(7)
    buffer_load_dwordx4 v5, s[28:31], s59 offen nt lds
    s_add_u32 s59, s83, 16384
    s_add_u32 m0, s60, 72704
    s_waitcnt vmcnt(7)
    buffer_load_dwordx4 v6, s[28:31], s59 offen nt lds
    s_waitcnt vmcnt(8) lgkmcnt(0)
    ds_read_b128 v[16:19], v120 offset:0
    ds_read_b128 v[32:35], v120 offset:4096
    ds_read_b128 v[20:23], v121 offset:0
    ds_read_b128 v[36:39], v121 offset:4096
    ds_read_b128 v[24:27], v122 offset:0
    ds_read_b128 v[40:43], v122 offset:4096
    ds_read_b128 v[28:31], v123 offset:0
    ds_read_b128 v[44:47], v123 offset:4096
    v_sub_u32 v112, v96, v143
    v_sub_u32 v113, v97, v143
    s_mov_b32 s56, 0x3e0293ee
    s_waitcnt lgkmcnt(0)
    v_mfma_f32_16x16x32_bf16 v[80:83], v[16:19], v[48:51], 0
    v_mfma_f32_16x16x32_bf16 v[84:87], v[16:19], v[64:67], 0
    v_mfma_f32_16x16x32_bf16 v[88:91], v[32:35], v[48:51], 0
    v_mfma_f32_16x16x32_bf16 v[92:95], v[32:35], v[64:67], 0
    v_mfma_f32_16x16x32_bf16 v[80:83], v[20:23], v[52:55], v[80:83]
    v_mfma_f32_16x16x32_bf16 v[84:87], v[20:23], v[68:71], v[84:87]
    v_mfma_f32_16x16x32_bf16 v[88:91], v[36:39], v[52:55], v[88:91]
    v_mfma_f32_16x16x32_bf16 v[92:95], v[36:39], v[68:71], v[92:95]
    v_mfma_f32_16x16x32_bf16 v[80:83], v[24:27], v[56:59], v[80:83]
    v_mfma_f32_16x16x32_bf16 v[84:87], v[24:27], v[72:75], v[84:87]
    v_mfma_f32_16x16x32_bf16 v[88:91], v[40:43], v[56:59], v[88:91]
    v_mfma_f32_16x16x32_bf16 v[92:95], v[40:43], v[72:75], v[92:95]
    v_mfma_f32_16x16x32_bf16 v[80:83], v[28:31], v[60:63], v[80:83]
    v_mfma_f32_16x16x32_bf16 v[84:87], v[28:31], v[76:79], v[84:87]
    v_mfma_f32_16x16x32_bf16 v[88:91], v[44:47], v[60:63], v[88:91]
    v_mfma_f32_16x16x32_bf16 v[92:95], v[44:47], v[76:79], v[92:95]
    s_nop 7
    v_cmp_lt_i32 vcc, 0, v112
    v_mul_f32 v80, s56, v80
    s_nop 0
    v_cndmask_b32 v80, v14, v80, vcc
    v_cmp_lt_i32 vcc, 1, v112
    v_mul_f32 v81, s56, v81
    s_nop 0
    v_cndmask_b32 v81, v14, v81, vcc
    v_cmp_lt_i32 vcc, 2, v112
    v_mul_f32 v82, s56, v82
    s_nop 0
    v_cndmask_b32 v82, v14, v82, vcc
    v_cmp_lt_i32 vcc, 3, v112
    v_mul_f32 v83, s56, v83
    s_nop 0
    v_cndmask_b32 v83, v14, v83, vcc
    v_cmp_lt_i32 vcc, 16, v112
    v_mul_f32 v88, s56, v88
    s_nop 0
    v_cndmask_b32 v88, v14, v88, vcc
    v_cmp_lt_i32 vcc, 17, v112
    v_mul_f32 v89, s56, v89
    s_nop 0
    v_cndmask_b32 v89, v14, v89, vcc
    v_cmp_lt_i32 vcc, 18, v112
    v_mul_f32 v90, s56, v90
    s_nop 0
    v_cndmask_b32 v90, v14, v90, vcc
    v_cmp_lt_i32 vcc, 19, v112
    v_mul_f32 v91, s56, v91
    s_nop 0
    v_cndmask_b32 v91, v14, v91, vcc
    v_cmp_lt_i32 vcc, 0, v113
    v_mul_f32 v84, s56, v84
    s_nop 0
    v_cndmask_b32 v84, v14, v84, vcc
    v_cmp_lt_i32 vcc, 1, v113
    v_mul_f32 v85, s56, v85
    s_nop 0
    v_cndmask_b32 v85, v14, v85, vcc
    v_cmp_lt_i32 vcc, 2, v113
    v_mul_f32 v86, s56, v86
    s_nop 0
    v_cndmask_b32 v86, v14, v86, vcc
    v_cmp_lt_i32 vcc, 3, v113
    v_mul_f32 v87, s56, v87
    s_nop 0
    v_cndmask_b32 v87, v14, v87, vcc
    v_cmp_lt_i32 vcc, 16, v113
    v_mul_f32 v92, s56, v92
    s_nop 0
    v_cndmask_b32 v92, v14, v92, vcc
    v_cmp_lt_i32 vcc, 17, v113
    v_mul_f32 v93, s56, v93
    s_nop 0
    v_cndmask_b32 v93, v14, v93, vcc
    v_cmp_lt_i32 vcc, 18, v113
    v_mul_f32 v94, s56, v94
    s_nop 0
    v_cndmask_b32 v94, v14, v94, vcc
    v_cmp_lt_i32 vcc, 19, v113
    v_mul_f32 v95, s56, v95
    s_nop 0
    v_cndmask_b32 v95, v14, v95, vcc
    v_max3_f32 v98, v80, v81, v82
    v_max3_f32 v98, v98, v83, v88
    v_max3_f32 v98, v98, v89, v90
    v_max_f32 v98, v98, v91
    v_max3_f32 v99, v84, v85, v86
    v_max3_f32 v99, v99, v87, v92
    v_max3_f32 v99, v99, v93, v94
    v_max_f32 v99, v99, v95
    s_branch L_maxw_W
L_idle1_W:
    s_waitcnt vmcnt(0)
    s_barrier
    s_cmp_lg_u32 s14, 7
    s_cbranch_scc1 L_nosig_Wb
    v_mov_b32 v102, 1
    s_mov_b64 exec, 1
    s_lshl_b32 s56, s48, 5
    s_add_u32 s56, s56, s17
    s_sub_u32 s56, s56, 8
    buffer_store_byte v102, off, s[40:43], s56 sc1
    s_mov_b64 exec, -1
L_nosig_Wb:
    v_mov_b32 v98, 0xff800000
    v_mov_b32 v99, 0xff800000
L_maxw_W:
    ds_write_b32 v8, v98 offset:0
    ds_write_b32 v8, v99 offset:2304
    s_waitcnt lgkmcnt(0)
    s_barrier
    s_mov_b32 s14, 99
    ds_read_b128 v[112:115], v9 offset:0
    ds_read_b128 v[116:119], v9 offset:16
    ds_read_b128 v[120:123], v9 offset:32
    ds_read_b128 v[124:127], v9 offset:48
    ds_read_b128 v[128:131], v9 offset:64
    ds_read_b128 v[132:135], v9 offset:80
    ds_read_b128 v[136:139], v9 offset:96
    ds_read_b128 v[140:143], v9 offset:112
    s_waitcnt lgkmcnt(0)
    v_max3_f32 v98, v112, v113, v114
    v_max3_f32 v98, v98, v115, v116
    v_max3_f32 v98, v98, v117, v118
    v_max3_f32 v98, v98, v119, v120
    v_max3_f32 v98, v98, v121, v122
    v_max3_f32 v98, v98, v123, v124
    v_max3_f32 v98, v98, v125, v126
    v_max3_f32 v98, v98, v127, v128
    v_max3_f32 v98, v98, v129, v130
    v_max3_f32 v98, v98, v131, v132
    v_max3_f32 v98, v98, v133, v134
    v_max3_f32 v98, v98, v135, v136
    v_max3_f32 v98, v98, v137, v138
    v_max3_f32 v98, v98, v139, v140
    v_max3_f32 v98, v98, v141, v142
    v_max_f32 v98, v98, v143
    ds_read_b128 v[112:115], v9 offset:2304
    ds_read_b128 v[116:119], v9 offset:2320
    ds_read_b128 v[120:123], v9 offset:2336
    ds_read_b128 v[124:127], v9 offset:2352
    ds_read_b128 v[128:131], v9 offset:2368
    ds_read_b128 v[132:135], v9 offset:2384
    ds_read_b128 v[136:139], v9 offset:2400
    ds_read_b128 v[140:143], v9 offset:2416
    s_waitcnt lgkmcnt(0)
    v_max3_f32 v99, v112, v113, v114
    v_max3_f32 v99, v99, v115, v116
    v_max3_f32 v99, v99, v117, v118
    v_max3_f32 v99, v99, v119, v120
    v_max3_f32 v99, v99, v121, v122
    v_max3_f32 v99, v99, v123, v124
    v_max3_f32 v99, v99, v125, v126
    v_max3_f32 v99, v99, v127, v128
    v_max3_f32 v99, v99, v129, v130
    v_max3_f32 v99, v99, v131, v132
    v_max3_f32 v99, v99, v133, v134
    v_max3_f32 v99, v99, v135, v136
    v_max3_f32 v99, v99, v137, v138
    v_max3_f32 v99, v99, v139, v140
    v_max3_f32 v99, v99, v141, v142
    v_max_f32 v99, v99, v143
    s_cmp_ge_u32 s51, s52
    s_cbranch_scc1 L_idle2_W
    v_sub_f32 v80, v80, v98
    v_sub_f32 v81, v81, v98
    v_sub_f32 v82, v82, v98
    v_sub_f32 v83, v83, v98
    v_sub_f32 v88, v88, v98
    v_sub_f32 v89, v89, v98
    v_sub_f32 v90, v90, v98
    v_sub_f32 v91, v91, v98
    v_sub_f32 v84, v84, v99
    v_sub_f32 v85, v85, v99
    v_sub_f32 v86, v86, v99
    v_sub_f32 v87, v87, v99
    v_sub_f32 v92, v92, v99
    v_sub_f32 v93, v93, v99
    v_sub_f32 v94, v94, v99
    v_sub_f32 v95, v95, v99
    v_exp_f32 v80, v80
    v_exp_f32 v81, v81
    v_exp_f32 v82, v82
    v_exp_f32 v83, v83
    v_exp_f32 v88, v88
    v_exp_f32 v89, v89
    v_exp_f32 v90, v90
    v_exp_f32 v91, v91
    v_exp_f32 v84, v84
    v_exp_f32 v85, v85
    v_exp_f32 v86, v86
    v_exp_f32 v87, v87
    v_exp_f32 v92, v92
    v_exp_f32 v93, v93
    v_exp_f32 v94, v94
    v_exp_f32 v95, v95
    s_nop 0
    v_add_f32 v100, v80, v81
    v_add_f32 v112, v82, v83
    v_add_f32 v113, v88, v89
    v_add_f32 v114, v90, v91
    v_add_f32 v100, v100, v112
    v_add_f32 v113, v113, v114
    v_add_f32 v100, v100, v113
    v_cvt_pk_bf16_f32 v104, v80, v81
    v_cvt_pk_bf16_f32 v105, v82, v83
    v_cvt_pk_bf16_f32 v106, v88, v89
    v_cvt_pk_bf16_f32 v107, v90, v91
    ds_write_b128 v10, v[104:107] offset:0
    v_add_f32 v101, v84, v85
    v_add_f32 v112, v86, v87
    v_add_f32 v113, v92, v93
    v_add_f32 v114, v94, v95
    v_add_f32 v101, v101, v112
    v_add_f32 v113, v113, v114
    v_add_f32 v101, v101, v113
    v_cvt_pk_bf16_f32 v108, v84, v85
    v_cvt_pk_bf16_f32 v109, v86, v87
    v_cvt_pk_bf16_f32 v110, v92, v93
    v_cvt_pk_bf16_f32 v111, v94, v95
    ds_write_b128 v10, v[108:111] offset:1024
    s_branch L_sumw_W
L_idle2_W:
    v_mov_b32 v100, 0
    v_mov_b32 v101, 0
L_sumw_W:
    ds_write_b32 v8, v100 offset:4608
    ds_write_b32 v8, v101 offset:6912
    s_waitcnt lgkmcnt(0)
    s_barrier
    v_lshlrev_b32 v104, 4, v1
    v_add_u32 v104, 131072, v104
    ds_read_b128 v[144:147], v104 offset:0
    ds_read_b128 v[148:151], v104 offset:1024
    ds_read_b128 v[152:155], v104 offset:2048
    ds_read_b128 v[156:159], v104 offset:3072
    ds_read_b128 v[160:163], v104 offset:4096
    ds_read_b128 v[164:167], v104 offset:5120
    ds_read_b128 v[168:171], v104 offset:6144
    ds_read_b128 v[172:175], v104 offset:7168
    ds_read_b128 v[176:179], v104 offset:8192
    ds_read_b128 v[180:183], v104 offset:9216
    ds_read_b128 v[184:187], v104 offset:10240
    ds_read_b128 v[188:191], v104 offset:11264
    ds_read_b128 v[192:195], v104 offset:12288
    ds_read_b128 v[196:199], v104 offset:13312
    ds_read_b128 v[200:203], v104 offset:14336
    ds_read_b128 v[204:207], v104 offset:15360
    v_mov_b32 v80, 0
    v_mov_b32 v81, 0
    v_mov_b32 v82, 0
    v_mov_b32 v83, 0
    v_mov_b32 v84, 0
    v_mov_b32 v85, 0
    v_mov_b32 v86, 0
    v_mov_b32 v87, 0
    s_add_u32 s63, s12, 8192
    s_cmp_lg_u32 s51, 7
    s_cbranch_scc1 L_nosum_W
    ds_read_b128 v[112:115], v9 offset:4608
    ds_read_b128 v[116:119], v9 offset:4624
    ds_read_b128 v[120:123], v9 offset:4640
    ds_read_b128 v[124:127], v9 offset:4656
    ds_read_b128 v[128:131], v9 offset:4672
    ds_read_b128 v[132:135], v9 offset:4688
    ds_read_b128 v[136:139], v9 offset:4704
    ds_read_b128 v[140:143], v9 offset:4720
    s_waitcnt lgkmcnt(0)
    v_add_f32 v112, v112, v113
    v_add_f32 v114, v114, v115
    v_add_f32 v116, v116, v117
    v_add_f32 v118, v118, v119
    v_add_f32 v120, v120, v121
    v_add_f32 v122, v122, v123
    v_add_f32 v124, v124, v125
    v_add_f32 v126, v126, v127
    v_add_f32 v128, v128, v129
    v_add_f32 v130, v130, v131
    v_add_f32 v132, v132, v133
    v_add_f32 v134, v134, v135
    v_add_f32 v136, v136, v137
    v_add_f32 v138, v138, v139
    v_add_f32 v140, v140, v141
    v_add_f32 v142, v142, v143
    v_add_f32 v112, v112, v114
    v_add_f32 v116, v116, v118
    v_add_f32 v120, v120, v122
    v_add_f32 v124, v124, v126
    v_add_f32 v128, v128, v130
    v_add_f32 v132, v132, v134
    v_add_f32 v136, v136, v138
    v_add_f32 v140, v140, v142
    v_add_f32 v112, v112, v116
    v_add_f32 v120, v120, v124
    v_add_f32 v128, v128, v132
    v_add_f32 v136, v136, v140
    v_add_f32 v112, v112, v120
    v_add_f32 v128, v128, v136
    v_add_f32 v112, v112, v128
    v_min_u32 v102, -2, v98
    v_min_u32 v103, -2, v112
    ds_read_b128 v[112:115], v9 offset:6912
    ds_read_b128 v[116:119], v9 offset:6928
    ds_read_b128 v[120:123], v9 offset:6944
    ds_read_b128 v[124:127], v9 offset:6960
    ds_read_b128 v[128:131], v9 offset:6976
    ds_read_b128 v[132:135], v9 offset:6992
    ds_read_b128 v[136:139], v9 offset:7008
    ds_read_b128 v[140:143], v9 offset:7024
    s_waitcnt lgkmcnt(0)
    v_add_f32 v112, v112, v113
    v_add_f32 v114, v114, v115
    v_add_f32 v116, v116, v117
    v_add_f32 v118, v118, v119
    v_add_f32 v120, v120, v121
    v_add_f32 v122, v122, v123
    v_add_f32 v124, v124, v125
    v_add_f32 v126, v126, v127
    v_add_f32 v128, v128, v129
    v_add_f32 v130, v130, v131
    v_add_f32 v132, v132, v133
    v_add_f32 v134, v134, v135
    v_add_f32 v136, v136, v137
    v_add_f32 v138, v138, v139
    v_add_f32 v140, v140, v141
    v_add_f32 v142, v142, v143
    v_add_f32 v112, v112, v114
    v_add_f32 v116, v116, v118
    v_add_f32 v120, v120, v122
    v_add_f32 v124, v124, v126
    v_add_f32 v128, v128, v130
    v_add_f32 v132, v132, v134
    v_add_f32 v136, v136, v138
    v_add_f32 v140, v140, v142
    v_add_f32 v112, v112, v116
    v_add_f32 v120, v120, v124
    v_add_f32 v128, v128, v132
    v_add_f32 v136, v136, v140
    v_add_f32 v112, v112, v120
    v_add_f32 v128, v128, v136
    v_add_f32 v112, v112, v128
    v_min_u32 v106, -2, v99
    v_min_u32 v107, -2, v112
    s_mov_b64 exec, 0xffff
    buffer_store_dwordx2 v[102:103], v254, s[44:47], s13 offen offset:0 sc1
    buffer_store_dwordx2 v[106:107], v254, s[44:47], s13 offen offset:128 sc1
    s_mov_b64 exec, -1
    s_waitcnt vmcnt(2)
    s_branch L_vbar_W
L_nosum_W:
    s_waitcnt vmcnt(0)
L_vbar_W:
    s_cmp_ge_i32 s52, 8
    s_cbranch_scc1 L_pb8_W
    s_cmp_ge_i32 s52, 7
    s_cbranch_scc1 L_pb7_W
    s_cmp_ge_i32 s52, 6
    s_cbranch_scc1 L_pb6_W
    s_cmp_ge_i32 s52, 5
    s_cbranch_scc1 L_pb5_W
    s_cmp_ge_i32 s52, 4
    s_cbranch_scc1 L_pb4_W
    s_cmp_ge_i32 s52, 3
    s_cbranch_scc1 L_pb3_W
    s_cmp_ge_i32 s52, 2
    s_cbranch_scc1 L_pb2_W
L_pb1_W:
    s_waitcnt lgkmcnt(0)
    s_barrier
    s_branch L_pr1_W
L_pb2_W:
    s_waitcnt lgkmcnt(0)
    s_barrier
    s_branch L_pr2_W
L_pb3_W:
    s_waitcnt lgkmcnt(0)
    s_barrier
    s_branch L_pr3_W
L_pb4_W:
    s_waitcnt lgkmcnt(0)
    s_barrier
    s_branch L_pr4_W
L_pb5_W:
    s_waitcnt lgkmcnt(0)
    s_barrier
    s_branch L_pr5_W
L_pb6_W:
    s_waitcnt lgkmcnt(0)
    s_barrier
    s_branch L_pr6_W
L_pb7_W:
    s_waitcnt lgkmcnt(0)
    s_barrier
    s_branch L_pr7_W
L_pb8_W:
    s_waitcnt lgkmcnt(0)
    s_barrier
L_pr8_W:
    ds_read_b64_tr_b16 v[236:237], v251 offset:57344
    ds_read_b64_tr_b16 v[238:239], v251 offset:61440
L_pr7_W:
    ds_read_b64_tr_b16 v[232:233], v251 offset:49152
    ds_read_b64_tr_b16 v[234:235], v251 offset:53248
L_pr6_W:
    ds_read_b64_tr_b16 v[228:229], v251 offset:40960
    ds_read_b64_tr_b16 v[230:231], v251 offset:45056
L_pr5_W:
    ds_read_b64_tr_b16 v[224:225], v251 offset:32768
    ds_read_b64_tr_b16 v[226:227], v251 offset:36864
L_pr4_W:
    ds_read_b64_tr_b16 v[220:221], v251 offset:24576
    ds_read_b64_tr_b16 v[222:223], v251 offset:28672
L_pr3_W:
    ds_read_b64_tr_b16 v[216:217], v251 offset:16384
    ds_read_b64_tr_b16 v[218:219], v251 offset:20480
L_pr2_W:
    ds_read_b64_tr_b16 v[212:213], v251 offset:8192
    ds_read_b64_tr_b16 v[214:215], v251 offset:12288
L_pr1_W:
    ds_read_b64_tr_b16 v[208:209], v251 offset:0
    ds_read_b64_tr_b16 v[210:211], v251 offset:4096
    s_cmp_le_i32 s52, 1
    s_cbranch_scc1 L_pm1_W
    s_cmp_le_i32 s52, 2
    s_cbranch_scc1 L_pm2_W
    s_cmp_le_i32 s52, 3
    s_cbranch_scc1 L_pm3_W
    s_cmp_le_i32 s52, 4
    s_cbranch_scc1 L_pm4_W
    s_cmp_le_i32 s52, 5
    s_cbranch_scc1 L_pm5_W
    s_cmp_le_i32 s52, 6
    s_cbranch_scc1 L_pm6_W
    s_cmp_le_i32 s52, 7
    s_cbranch_scc1 L_pm7_W
L_pm8_W:
    s_waitcnt lgkmcnt(14)
    v_mfma_f32_16x16x32_bf16 v[80:83], v[236:239], v[200:203], v[80:83]
    v_mfma_f32_16x16x32_bf16 v[84:87], v[236:239], v[204:207], v[84:87]
L_pm7_W:
    s_waitcnt lgkmcnt(12)
    v_mfma_f32_16x16x32_bf16 v[80:83], v[232:235], v[192:195], v[80:83]
    v_mfma_f32_16x16x32_bf16 v[84:87], v[232:235], v[196:199], v[84:87]
L_pm6_W:
    s_waitcnt lgkmcnt(10)
    v_mfma_f32_16x16x32_bf16 v[80:83], v[228:231], v[184:187], v[80:83]
    v_mfma_f32_16x16x32_bf16 v[84:87], v[228:231], v[188:191], v[84:87]
L_pm5_W:
    s_waitcnt lgkmcnt(8)
    v_mfma_f32_16x16x32_bf16 v[80:83], v[224:227], v[176:179], v[80:83]
    v_mfma_f32_16x16x32_bf16 v[84:87], v[224:227], v[180:183], v[84:87]
L_pm4_W:
    s_waitcnt lgkmcnt(6)
    v_mfma_f32_16x16x32_bf16 v[80:83], v[220:223], v[168:171], v[80:83]
    v_mfma_f32_16x16x32_bf16 v[84:87], v[220:223], v[172:175], v[84:87]
L_pm3_W:
    s_waitcnt lgkmcnt(4)
    v_mfma_f32_16x16x32_bf16 v[80:83], v[216:219], v[160:163], v[80:83]
    v_mfma_f32_16x16x32_bf16 v[84:87], v[216:219], v[164:167], v[84:87]
L_pm2_W:
    s_waitcnt lgkmcnt(2)
    v_mfma_f32_16x16x32_bf16 v[80:83], v[212:215], v[152:155], v[80:83]
    v_mfma_f32_16x16x32_bf16 v[84:87], v[212:215], v[156:159], v[84:87]
L_pm1_W:
    s_waitcnt lgkmcnt(0)
    v_mfma_f32_16x16x32_bf16 v[80:83], v[208:211], v[144:147], v[80:83]
    v_mfma_f32_16x16x32_bf16 v[84:87], v[208:211], v[148:151], v[84:87]
    s_nop 7
    v_min_u32 v80, -2, v80
    v_min_u32 v81, -2, v81
    v_min_u32 v82, -2, v82
    v_min_u32 v83, -2, v83
    v_min_u32 v84, -2, v84
    v_min_u32 v85, -2, v85
    v_min_u32 v86, -2, v86
    v_min_u32 v87, -2, v87
    buffer_store_dwordx4 v[80:83], v13, s[44:47], s12 offen sc1
    buffer_store_dwordx4 v[84:87], v13, s[44:47], s63 offen sc1
    s_branch L_tail
L_fallback:
    s_mov_b64 s[78:79], -1
    s_mov_b32 s80, -1
    v_add_u32 v131, 15, v250
    v_add_u32 v132, -1, v250
    v_cmp_gt_u32 vcc, 0x800, v132
    v_lshrrev_b32 v131, 4, v131
    v_mov_b32 v128, 0x80
    s_nop 0
    v_cndmask_b32 v128, v128, v131, vcc
    v_subrev_u32 v131, 63, v128
    v_max_i32 v131, 0, v131
    v_lshrrev_b32 v126, 1, v131
    v_subrev_u32 v131, s15, v126
    v_max_i32 v131, 0, v131
    v_cndmask_b32 v129, 0, v131, s[92:93]
    v_cndmask_b32 v130, 0, v131, s[92:93]
    v_cmp_gt_u32 s[58:59], 3, v131
    s_nop 0
    v_add_u32_dpp v130, v130, v130 row_shr:1 row_mask:0xf bank_mask:0xf bound_ctrl:0
    s_nop 1
    v_add_u32_dpp v130, v130, v130 row_shr:2 row_mask:0xf bank_mask:0xf bound_ctrl:0
    s_nop 1
    v_add_u32_dpp v130, v130, v130 row_shr:4 row_mask:0xf bank_mask:0xf bound_ctrl:0
    s_nop 1
    v_readlane_b32 s7, v130, 3
    v_readlane_b32 s8, v130, 7
    v_cmp_lt_u32 vcc, 3, v1
    s_nop 2
    s_and_b32 s58, s58, 0x7e
    s_cselect_b32 s57, s7, 0
    s_cselect_b32 s7, s7, s8
    s_cselect_b32 s11, 15, 0xff
    s_sub_u32 s8, s8, s7
    v_mov_b32 v131, s57
    v_cndmask_b32 v131, 0, v131, vcc
    v_add3_u32 v132, s7, v1, 3
    v_add3_u32 v135, s8, v1, 3
    v_mul_u32_u24 v132, v132, v255
    v_mul_u32_u24 v135, v135, v255
    v_lshrrev_b32 v132, 18, v132
    v_lshrrev_b32 v135, 18, v135
    v_add_u32 v135, v135, v132
    v_cmp_ge_u32 vcc, s96, v135
    v_sub_u32 v134, v130, v131
    v_sub_u32 v133, v134, v129
    s_or_b32 s56, vcc_lo, 16
    s_ff1_i32_b32 s56, s56
    v_readlane_b32 s10, v132, s56
    v_readlane_b32 s55, v135, s56
    v_readlane_b32 s100, v255, s56
    s_add_u32 s9, s56, 4
    s_nop 2
    s_add_u32 s55, s55, s16
    s_mov_b32 s50, 0
    s_mov_b32 s89, 128
L_fbloop:
    s_mov_b32 s3, s50
    s_branch L_narrow
L_st2:
    s_branch L_bk
L_ptype:
    s_waitcnt vmcnt(11)
    s_cmp_eq_u32 s54, 1
    s_cbranch_scc1 L_sw_N
    s_waitcnt vmcnt(3)
L_sw_N:
    v_add_u32 v131, 15, v250
    v_add_u32 v132, -1, v250
    v_cmp_gt_u32 vcc, 0x800, v132
    v_lshrrev_b32 v131, 4, v131
    v_mov_b32 v128, 0x80
    s_nop 0
    v_cndmask_b32 v128, v128, v131, vcc
    v_subrev_u32 v131, 63, v128
    v_max_i32 v131, 0, v131
    v_lshrrev_b32 v126, 1, v131
    v_subrev_u32 v131, s15, v126
    v_max_i32 v131, 0, v131
    v_cndmask_b32 v129, 0, v131, s[92:93]
    v_cndmask_b32 v130, 0, v131, s[92:93]
    v_cmp_gt_u32 s[58:59], 3, v131
    s_nop 0
    v_add_u32_dpp v130, v130, v130 row_shr:1 row_mask:0xf bank_mask:0xf bound_ctrl:0
    s_nop 1
    v_add_u32_dpp v130, v130, v130 row_shr:2 row_mask:0xf bank_mask:0xf bound_ctrl:0
    s_nop 1
    v_add_u32_dpp v130, v130, v130 row_shr:4 row_mask:0xf bank_mask:0xf bound_ctrl:0
    s_nop 1
    v_readlane_b32 s7, v130, 3
    v_readlane_b32 s8, v130, 7
    v_cmp_lt_u32 vcc, 3, v1
    s_nop 2
    s_and_b32 s58, s58, 0x7e
    s_cselect_b32 s57, s7, 0
    s_cselect_b32 s7, s7, s8
    s_cselect_b32 s11, 15, 0xff
    s_sub_u32 s8, s8, s7
    v_mov_b32 v131, s57
    v_cndmask_b32 v131, 0, v131, vcc
    v_add3_u32 v132, s7, v1, 3
    v_add3_u32 v135, s8, v1, 3
    v_mul_u32_u24 v132, v132, v255
    v_mul_u32_u24 v135, v135, v255
    v_lshrrev_b32 v132, 18, v132
    v_lshrrev_b32 v135, 18, v135
    v_add_u32 v135, v135, v132
    v_cmp_ge_u32 vcc, s96, v135
    v_sub_u32 v134, v130, v131
    v_sub_u32 v133, v134, v129
    s_or_b32 s56, vcc_lo, 16
    s_ff1_i32_b32 s56, s56
    v_readlane_b32 s10, v132, s56
    v_readlane_b32 s55, v135, s56
    v_readlane_b32 s100, v255, s56
    s_add_u32 s9, s56, 4
    s_nop 2
    s_add_u32 s55, s55, s16
    s_cmp_ge_u32 s49, s55
    s_cbranch_scc1 L_inact
    s_cmp_ge_u32 s99, s10
    s_cselect_b32 s56, s10, 0
    s_cselect_b32 s57, s8, s7
    s_cselect_b32 s11, 0xf0, s11
    s_sub_u32 s99, s99, s56
    s_mul_i32 s56, s99, s9
    s_add_u32 s59, s56, s51
    v_cmp_lt_u32 vcc, s59, v134
    v_cmp_lt_u32 s[60:61], s56, v134
    s_sub_u32 s57, s57, s56
    s_min_u32 s52, s57, s9
    s_and_b32 s58, s11, vcc_lo
    s_ff1_i32_b32 s50, s58
    s_and_b32 s50, s50, 7
    s_and_b32 s60, s11, s60
    s_ff1_i32_b32 s3, s60
    v_readlane_b32 s57, v133, s50
    v_readlane_b32 s89, v128, s50
    s_nop 3
    s_sub_u32 s6, s59, s57
    s_lshl_b32 s53, s6, 1
    s_add_u32 s53, s53, 64
L_narrow:
    s_and_b32 s56, s50, 1
    s_lshl_b32 s56, s56, 5
    s_add_u32 s56, s56, s6
    s_and_b32 s56, s56, 63
    v_readlane_b32 s82, v240, s56
    v_readlane_b32 s83, v241, s56
    v_readlane_b32 s60, v242, s56
    v_readlane_b32 s61, v243, s56
    v_readlane_b32 s62, v244, s56
    v_readlane_b32 s63, v245, s56
    v_readlane_b32 s64, v246, s56
    v_readlane_b32 s65, v247, s56
    v_readlane_b32 s90, v250, s50
    s_lshr_b32 s57, s50, 1
    s_add_u32 s58, s53, 1
    s_nop 2
    s_cmp_eq_u32 s57, 1
    s_cselect_b32 s82, s60, s82
    s_cselect_b32 s83, s61, s83
    s_cmp_eq_u32 s57, 2
    s_cselect_b32 s82, s62, s82
    s_cselect_b32 s83, s63, s83
    s_cmp_eq_u32 s57, 3
    s_cselect_b32 s82, s64, s82
    s_cselect_b32 s83, s65, s83
    s_cmp_lt_u32 s58, s89
    s_cselect_b32 s83, s83, s82
    s_lshl_b32 s82, s82, 15
    s_lshl_b32 s83, s83, 15
    s_cmp_eq_u32 s54, 0
    s_cbranch_scc1 L_norm_N
    s_mov_b32 s54, 0
    s_sub_u32 s56, s51, s3
    s_and_b32 s56, s56, 3
    s_add_u32 s56, s56, s3
    s_min_u32 s56, s56, 7
    s_lshl_b32 s56, s56, 13
    s_cmp_ge_u32 s51, 4
    s_cselect_b32 s56, s80, s56
    s_cmp_lg_u32 s56, s80
    s_cbranch_scc1 L_mis_N
    s_cmp_ge_u32 s51, s52
    s_cbranch_scc1 L_nok_N
    s_cmp_eq_u64 s[82:83], s[78:79]
    s_cbranch_scc1 L_nok_N
    s_cmp_eq_u32 s78, -1
    s_cbranch_scc1 L_noq_N
L_mis_N:
    s_waitcnt vmcnt(0)
L_norm_N:
    s_cmp_ge_u32 s51, 4
    s_cbranch_scc1 L_noq_N
    s_and_b32 s56, s51, 3
    s_lshl_b32 s56, s56, 2
    v_add_u32 v142, s56, v2
    v_xor_b32 v142, v142, v3
    v_lshl_add_u32 v142, v142, 4, v15
    s_sub_u32 s56, s51, s3
    s_and_b32 s56, s56, 3
    s_add_u32 s56, s56, s3
    s_min_u32 s56, s56, 7
    s_lshl_b32 s56, s56, 13
    s_lshl_b32 s57, s51, 10
    s_add_u32 m0, s57, 131072
    s_nop 0
    buffer_load_dwordx4 v142, s[20:23], s56 offen lds
L_noq_N:
    s_cmp_ge_u32 s51, s52
    s_cbranch_scc1 L_nok_N
    s_lshl_b32 s60, s51, 13
    s_add_u32 m0, s60, 0
    s_nop 0
    buffer_load_dwordx4 v4, s[24:27], s82 offen nt lds
    s_add_u32 m0, s60, 1024
    s_nop 0
    buffer_load_dwordx4 v7, s[24:27], s82 offen nt lds
    s_add_u32 m0, s60, 2048
    s_nop 0
    buffer_load_dwordx4 v12, s[24:27], s82 offen nt lds
    s_add_u32 m0, s60, 3072
    s_nop 0
    buffer_load_dwordx4 v0, s[24:27], s82 offen nt lds
    s_add_u32 m0, s60, 4096
    s_nop 0
    buffer_load_dwordx4 v4, s[24:27], s83 offen nt lds
    s_add_u32 m0, s60, 5120
    s_nop 0
    buffer_load_dwordx4 v7, s[24:27], s83 offen nt lds
    s_add_u32 m0, s60, 6144
    s_nop 0
    buffer_load_dwordx4 v12, s[24:27], s83 offen nt lds
    s_add_u32 m0, s60, 7168
    s_nop 0
    buffer_load_dwordx4 v0, s[24:27], s83 offen nt lds
L_nok_N:
    s_cmp_lt_u32 s49, s16
    s_cbranch_scc1 L_fbslot
    v_mul_u32_u24 v131, s100, v133
    v_add_u32 v132, -1, v134
    v_max_i32 v132, 0, v132
    v_mul_u32_u24 v132, s100, v132
    v_lshrrev_b32 v131, 18, v131
    v_lshrrev_b32 v132, 18, v132
    v_cmp_ge_u32 vcc, s99, v131
    v_cmp_le_u32 s[56:57], s99, v132
    v_cmp_lt_u32 s[58:59], 0, v129
    s_mov_b32 s101, 0
    s_nop 0
    s_and_b32 s56, s56, vcc_lo
    s_and_b32 s56, s56, s58
    s_and_b32 s62, s56, s11
    s_branch L_slotdone
L_fbslot:
    s_lshl_b32 s62, 1, s50
    s_lshr_b32 s101, s50, 2
L_slotdone:
    s_lshr_b32 s63, s62, 4
    s_or_b32 s62, s62, s63
    v_lshrrev_b32 v140, 2, v3
    v_lshrrev_b32 v140, v140, s62
    v_and_b32 v140, 1, v140
    v_cmp_ne_u32 s[4:5], 0, v140
    s_add_u32 s56, s17, s97
    s_sub_u32 s56, s56, 8
    s_cmp_ge_u32 s56, s55
    s_cbranch_scc1 L_no2_N
    s_cmp_lg_u32 s14, s51
    s_cbranch_scc1 L_no2_N
    s_sub_u32 s56, s56, s16
    s_add_u32 s57, s56, 16
    s_lshl_b32 s57, s57, 13
    s_mul_i32 s58, s48, 393216
    s_add_u32 s57, s57, s58
    s_add_u32 s56, s56, 8
    s_lshl_b32 s56, s56, 8
    s_mul_i32 s58, s48, 10240
    s_add_u32 s56, s56, s58
    s_add_u32 s56, s56, 3145728
    v_mov_b32 v144, -1
    v_mov_b32 v145, -1
    v_mov_b32 v146, -1
    v_mov_b32 v147, -1
    buffer_store_dwordx4 v[144:147], v13, s[44:47], s57 offen sc1
    s_mov_b64 exec, 0xffff
    buffer_store_dwordx2 v[144:145], v254, s[44:47], s56 offen sc1
    s_mov_b64 exec, -1
    s_waitcnt vmcnt(0)
L_no2_N:
    s_cmp_ge_u32 s51, s52
    s_cbranch_scc1 L_idle1_N
    s_lshl_b32 s57, s53, 4
    v_lshl_add_u32 v143, v2, 2, s57
    s_and_b32 s56, s50, 3
    v_lshrrev_b32 v140, 2, v3
    v_cmp_eq_u32 vcc, s56, v140
    v_mov_b32 v140, s90
    v_mov_b32 v141, 0xceabfb8f
    v_mov_b32 v96, 0xc0000000
    v_mov_b32 v14, 0xff800000
    v_cndmask_b32 v96, v96, v140, vcc
    v_cndmask_b32 v14, v14, v141, vcc
    s_lshl_b32 s57, s51, 13
    v_add_u32 v136, 0, v2
    v_xor_b32 v136, v136, v3
    v_lshlrev_b32 v136, 4, v136
    v_lshl_add_u32 v136, v3, 8, v136
    v_add_u32 v120, s57, v136
    v_add_u32 v136, 131072, v136
    v_add_u32 v137, 4, v2
    v_xor_b32 v137, v137, v3
    v_lshlrev_b32 v137, 4, v137
    v_lshl_add_u32 v137, v3, 8, v137
    v_add_u32 v121, s57, v137
    v_add_u32 v137, 131072, v137
    v_add_u32 v138, 8, v2
    v_xor_b32 v138, v138, v3
    v_lshlrev_b32 v138, 4, v138
    v_lshl_add_u32 v138, v3, 8, v138
    v_add_u32 v122, s57, v138
    v_add_u32 v138, 131072, v138
    v_add_u32 v139, 12, v2
    v_xor_b32 v139, v139, v3
    v_lshlrev_b32 v139, 4, v139
    v_lshl_add_u32 v139, v3, 8, v139
    v_add_u32 v123, s57, v139
    v_add_u32 v139, 131072, v139
    s_waitcnt vmcnt(8)
    s_barrier
    s_cmp_lg_u32 s14, 7
    s_cbranch_scc1 L_nosig_Na
    v_mov_b32 v102, 1
    s_mov_b64 exec, 1
    s_lshl_b32 s56, s48, 5
    s_add_u32 s56, s56, s17
    s_sub_u32 s56, s56, 8
    buffer_store_byte v102, off, s[40:43], s56 sc1
    s_mov_b64 exec, -1
L_nosig_Na:
    ds_read_b128 v[48:51], v136 offset:0
    ds_read_b128 v[52:55], v137 offset:0
    ds_read_b128 v[56:59], v138 offset:0
    ds_read_b128 v[60:63], v139 offset:0
    s_lshl_b32 s60, s51, 13
    s_lshl_b32 s60, s51, 13
    s_add_u32 s59, s82, 0
    s_add_u32 m0, s60, 65536
    s_waitcnt vmcnt(7)
    buffer_load_dwordx4 v5, s[28:31], s59 offen nt lds
    s_add_u32 s59, s82, 0
    s_add_u32 m0, s60, 66560
    s_waitcnt vmcnt(7)
    buffer_load_dwordx4 v6, s[28:31], s59 offen nt lds
    s_add_u32 s59, s82, 16384
    s_add_u32 m0, s60, 67584
    s_waitcnt vmcnt(7)
    buffer_load_dwordx4 v5, s[28:31], s59 offen nt lds
    s_add_u32 s59, s82, 16384
    s_add_u32 m0, s60, 68608
    s_waitcnt vmcnt(7)
    buffer_load_dwordx4 v6, s[28:31], s59 offen nt lds
    s_add_u32 s59, s83, 0
    s_add_u32 m0, s60, 69632
    s_waitcnt vmcnt(7)
    buffer_load_dwordx4 v5, s[28:31], s59 offen nt lds
    s_add_u32 s59, s83, 0
    s_add_u32 m0, s60, 70656
    s_waitcnt vmcnt(7)
    buffer_load_dwordx4 v6, s[28:31], s59 offen nt lds
    s_add_u32 s59, s83, 16384
    s_add_u32 m0, s60, 71680
    s_waitcnt vmcnt(7)
    buffer_load_dwordx4 v5, s[28:31], s59 offen nt lds
    s_add_u32 s59, s83, 16384
    s_add_u32 m0, s60, 72704
    s_waitcnt vmcnt(7)
    buffer_load_dwordx4 v6, s[28:31], s59 offen nt lds
    s_waitcnt vmcnt(8) lgkmcnt(0)
    ds_read_b128 v[16:19], v120 offset:0
    ds_read_b128 v[32:35], v120 offset:4096
    ds_read_b128 v[20:23], v121 offset:0
    ds_read_b128 v[36:39], v121 offset:4096
    ds_read_b128 v[24:27], v122 offset:0
    ds_read_b128 v[40:43], v122 offset:4096
    ds_read_b128 v[28:31], v123 offset:0
    ds_read_b128 v[44:47], v123 offset:4096
    v_sub_u32 v112, v96, v143
    s_mov_b32 s56, 0x3e0293ee
    s_waitcnt lgkmcnt(0)
    v_mfma_f32_16x16x32_bf16 v[80:83], v[16:19], v[48:51], 0
    v_mfma_f32_16x16x32_bf16 v[88:91], v[32:35], v[48:51], 0
    v_mfma_f32_16x16x32_bf16 v[80:83], v[20:23], v[52:55], v[80:83]
    v_mfma_f32_16x16x32_bf16 v[88:91], v[36:39], v[52:55], v[88:91]
    v_mfma_f32_16x16x32_bf16 v[80:83], v[24:27], v[56:59], v[80:83]
    v_mfma_f32_16x16x32_bf16 v[88:91], v[40:43], v[56:59], v[88:91]
    v_mfma_f32_16x16x32_bf16 v[80:83], v[28:31], v[60:63], v[80:83]
    v_mfma_f32_16x16x32_bf16 v[88:91], v[44:47], v[60:63], v[88:91]
    s_nop 7
    v_cmp_lt_i32 vcc, 0, v112
    v_mul_f32 v80, s56, v80
    s_nop 0
    v_cndmask_b32 v80, v14, v80, vcc
    v_cmp_lt_i32 vcc, 1, v112
    v_mul_f32 v81, s56, v81
    s_nop 0
    v_cndmask_b32 v81, v14, v81, vcc
    v_cmp_lt_i32 vcc, 2, v112
    v_mul_f32 v82, s56, v82
    s_nop 0
    v_cndmask_b32 v82, v14, v82, vcc
    v_cmp_lt_i32 vcc, 3, v112
    v_mul_f32 v83, s56, v83
    s_nop 0
    v_cndmask_b32 v83, v14, v83, vcc
    v_cmp_lt_i32 vcc, 16, v112
    v_mul_f32 v88, s56, v88
    s_nop 0
    v_cndmask_b32 v88, v14, v88, vcc
    v_cmp_lt_i32 vcc, 17, v112
    v_mul_f32 v89, s56, v89
    s_nop 0
    v_cndmask_b32 v89, v14, v89, vcc
    v_cmp_lt_i32 vcc, 18, v112
    v_mul_f32 v90, s56, v90
    s_nop 0
    v_cndmask_b32 v90, v14, v90, vcc
    v_cmp_lt_i32 vcc, 19, v112
    v_mul_f32 v91, s56, v91
    s_nop 0
    v_cndmask_b32 v91, v14, v91, vcc
    v_max3_f32 v98, v80, v81, v82
    v_max3_f32 v98, v98, v83, v88
    v_max3_f32 v98, v98, v89, v90
    v_max_f32 v98, v98, v91
    s_branch L_maxw_N
L_idle1_N:
    s_waitcnt vmcnt(0)
    s_barrier
    s_cmp_lg_u32 s14, 7
    s_cbranch_scc1 L_nosig_Nb
    v_mov_b32 v102, 1
    s_mov_b64 exec, 1
    s_lshl_b32 s56, s48, 5
    s_add_u32 s56, s56, s17
    s_sub_u32 s56, s56, 8
    buffer_store_byte v102, off, s[40:43], s56 sc1
    s_mov_b64 exec, -1
L_nosig_Nb:
    v_mov_b32 v98, 0xff800000
L_maxw_N:
    ds_write_b32 v8, v98 offset:0
    s_waitcnt lgkmcnt(0)
    s_barrier
    s_mov_b32 s14, 99
    ds_read_b128 v[112:115], v9 offset:0
    ds_read_b128 v[116:119], v9 offset:16
    ds_read_b128 v[120:123], v9 offset:32
    ds_read_b128 v[124:127], v9 offset:48
    ds_read_b128 v[128:131], v9 offset:64
    ds_read_b128 v[132:135], v9 offset:80
    ds_read_b128 v[136:139], v9 offset:96
    ds_read_b128 v[140:143], v9 offset:112
    s_waitcnt lgkmcnt(0)
    v_max3_f32 v98, v112, v113, v114
    v_max3_f32 v98, v98, v115, v116
    v_max3_f32 v98, v98, v117, v118
    v_max3_f32 v98, v98, v119, v120
    v_max3_f32 v98, v98, v121, v122
    v_max3_f32 v98, v98, v123, v124
    v_max3_f32 v98, v98, v125, v126
    v_max3_f32 v98, v98, v127, v128
    v_max3_f32 v98, v98, v129, v130
    v_max3_f32 v98, v98, v131, v132
    v_max3_f32 v98, v98, v133, v134
    v_max3_f32 v98, v98, v135, v136
    v_max3_f32 v98, v98, v137, v138
    v_max3_f32 v98, v98, v139, v140
    v_max3_f32 v98, v98, v141, v142
    v_max_f32 v98, v98, v143
    s_cmp_ge_u32 s51, s52
    s_cbranch_scc1 L_idle2_N
    v_sub_f32 v80, v80, v98
    v_sub_f32 v81, v81, v98
    v_sub_f32 v82, v82, v98
    v_sub_f32 v83, v83, v98
    v_sub_f32 v88, v88, v98
    v_sub_f32 v89, v89, v98
    v_sub_f32 v90, v90, v98
    v_sub_f32 v91, v91, v98
    v_exp_f32 v80, v80
    v_exp_f32 v81, v81
    v_exp_f32 v82, v82
    v_exp_f32 v83, v83
    v_exp_f32 v88, v88
    v_exp_f32 v89, v89
    v_exp_f32 v90, v90
    v_exp_f32 v91, v91
    s_nop 0
    v_add_f32 v100, v80, v81
    v_add_f32 v112, v82, v83
    v_add_f32 v113, v88, v89
    v_add_f32 v114, v90, v91
    v_add_f32 v100, v100, v112
    v_add_f32 v113, v113, v114
    v_add_f32 v100, v100, v113
    v_cvt_pk_bf16_f32 v104, v80, v81
    v_cvt_pk_bf16_f32 v105, v82, v83
    v_cvt_pk_bf16_f32 v106, v88, v89
    v_cvt_pk_bf16_f32 v107, v90, v91
    ds_write_b128 v10, v[104:107] offset:0
    s_branch L_sumw_N
L_idle2_N:
    v_mov_b32 v100, 0
L_sumw_N:
    ds_write_b32 v8, v100 offset:4608
    s_waitcnt lgkmcnt(0)
    s_barrier
    v_lshlrev_b32 v104, 4, v1
    v_add_u32 v104, 131072, v104
    ds_read_b128 v[144:147], v104 offset:0
    ds_read_b128 v[152:155], v104 offset:2048
    ds_read_b128 v[160:163], v104 offset:4096
    ds_read_b128 v[168:171], v104 offset:6144
    ds_read_b128 v[176:179], v104 offset:8192
    ds_read_b128 v[184:187], v104 offset:10240
    ds_read_b128 v[192:195], v104 offset:12288
    ds_read_b128 v[200:203], v104 offset:14336
    v_mov_b32 v80, 0
    v_mov_b32 v81, 0
    v_mov_b32 v82, 0
    v_mov_b32 v83, 0
    s_lshl_b32 s63, s101, 13
    s_add_u32 s63, s63, s12
    s_lshl_b32 s60, s101, 7
    s_add_u32 s60, s60, s13
    s_cmp_lg_u32 s51, 7
    s_cbranch_scc1 L_nosum_N
    ds_read_b128 v[112:115], v9 offset:4608
    ds_read_b128 v[116:119], v9 offset:4624
    ds_read_b128 v[120:123], v9 offset:4640
    ds_read_b128 v[124:127], v9 offset:4656
    ds_read_b128 v[128:131], v9 offset:4672
    ds_read_b128 v[132:135], v9 offset:4688
    ds_read_b128 v[136:139], v9 offset:4704
    ds_read_b128 v[140:143], v9 offset:4720
    s_waitcnt lgkmcnt(0)
    v_add_f32 v112, v112, v113
    v_add_f32 v114, v114, v115
    v_add_f32 v116, v116, v117
    v_add_f32 v118, v118, v119
    v_add_f32 v120, v120, v121
    v_add_f32 v122, v122, v123
    v_add_f32 v124, v124, v125
    v_add_f32 v126, v126, v127
    v_add_f32 v128, v128, v129
    v_add_f32 v130, v130, v131
    v_add_f32 v132, v132, v133
    v_add_f32 v134, v134, v135
    v_add_f32 v136, v136, v137
    v_add_f32 v138, v138, v139
    v_add_f32 v140, v140, v141
    v_add_f32 v142, v142, v143
    v_add_f32 v112, v112, v114
    v_add_f32 v116, v116, v118
    v_add_f32 v120, v120, v122
    v_add_f32 v124, v124, v126
    v_add_f32 v128, v128, v130
    v_add_f32 v132, v132, v134
    v_add_f32 v136, v136, v138
    v_add_f32 v140, v140, v142
    v_add_f32 v112, v112, v116
    v_add_f32 v120, v120, v124
    v_add_f32 v128, v128, v132
    v_add_f32 v136, v136, v140
    v_add_f32 v112, v112, v120
    v_add_f32 v128, v128, v136
    v_add_f32 v112, v112, v128
    v_min_u32 v102, -2, v98
    v_min_u32 v103, -2, v112
    s_and_b32 exec_lo, s4, 0xffff
    s_mov_b32 exec_hi, 0
    buffer_store_dwordx2 v[102:103], v254, s[44:47], s60 offen offset:0 sc1
    s_mov_b64 exec, -1
    s_waitcnt vmcnt(1)
    s_branch L_vbar_N
L_nosum_N:
    s_waitcnt vmcnt(0)
L_vbar_N:
    s_cmp_ge_i32 s52, 8
    s_cbranch_scc1 L_pb8_N
    s_cmp_ge_i32 s52, 7
    s_cbranch_scc1 L_pb7_N
    s_cmp_ge_i32 s52, 6
    s_cbranch_scc1 L_pb6_N
    s_cmp_ge_i32 s52, 5
    s_cbranch_scc1 L_pb5_N
    s_cmp_ge_i32 s52, 4
    s_cbranch_scc1 L_pb4_N
    s_cmp_ge_i32 s52, 3
    s_cbranch_scc1 L_pb3_N
    s_cmp_ge_i32 s52, 2
    s_cbranch_scc1 L_pb2_N
L_pb1_N:
    s_waitcnt lgkmcnt(0)
    s_barrier
    s_branch L_pr1_N
L_pb2_N:
    s_waitcnt lgkmcnt(0)
    s_barrier
    s_branch L_pr2_N
L_pb3_N:
    s_waitcnt lgkmcnt(0)
    s_barrier
    s_branch L_pr3_N
L_pb4_N:
    s_waitcnt lgkmcnt(0)
    s_barrier
    s_branch L_pr4_N
L_pb5_N:
    s_waitcnt lgkmcnt(0)
    s_barrier
    s_branch L_pr5_N
L_pb6_N:
    s_waitcnt lgkmcnt(0)
    s_barrier
    s_branch L_pr6_N
L_pb7_N:
    s_waitcnt lgkmcnt(0)
    s_barrier
    s_branch L_pr7_N
L_pb8_N:
    s_waitcnt lgkmcnt(0)
    s_barrier
L_pr8_N:
    ds_read_b64_tr_b16 v[236:237], v251 offset:57344
    ds_read_b64_tr_b16 v[238:239], v251 offset:61440
L_pr7_N:
    ds_read_b64_tr_b16 v[232:233], v251 offset:49152
    ds_read_b64_tr_b16 v[234:235], v251 offset:53248
L_pr6_N:
    ds_read_b64_tr_b16 v[228:229], v251 offset:40960
    ds_read_b64_tr_b16 v[230:231], v251 offset:45056
L_pr5_N:
    ds_read_b64_tr_b16 v[224:225], v251 offset:32768
    ds_read_b64_tr_b16 v[226:227], v251 offset:36864
L_pr4_N:
    ds_read_b64_tr_b16 v[220:221], v251 offset:24576
    ds_read_b64_tr_b16 v[222:223], v251 offset:28672
L_pr3_N:
    ds_read_b64_tr_b16 v[216:217], v251 offset:16384
    ds_read_b64_tr_b16 v[218:219], v251 offset:20480
L_pr2_N:
    ds_read_b64_tr_b16 v[212:213], v251 offset:8192
    ds_read_b64_tr_b16 v[214:215], v251 offset:12288
L_pr1_N:
    ds_read_b64_tr_b16 v[208:209], v251 offset:0
    ds_read_b64_tr_b16 v[210:211], v251 offset:4096
    s_cmp_le_i32 s52, 1
    s_cbranch_scc1 L_pm1_N
    s_cmp_le_i32 s52, 2
    s_cbranch_scc1 L_pm2_N
    s_cmp_le_i32 s52, 3
    s_cbranch_scc1 L_pm3_N
    s_cmp_le_i32 s52, 4
    s_cbranch_scc1 L_pm4_N
    s_cmp_le_i32 s52, 5
    s_cbranch_scc1 L_pm5_N
    s_cmp_le_i32 s52, 6
    s_cbranch_scc1 L_pm6_N
    s_cmp_le_i32 s52, 7
    s_cbranch_scc1 L_pm7_N
L_pm8_N:
    s_waitcnt lgkmcnt(14)
    v_mfma_f32_16x16x32_bf16 v[80:83], v[236:239], v[200:203], v[80:83]
L_pm7_N:
    s_waitcnt lgkmcnt(12)
    v_mfma_f32_16x16x32_bf16 v[80:83], v[232:235], v[192:195], v[80:83]
L_pm6_N:
    s_waitcnt lgkmcnt(10)
    v_mfma_f32_16x16x32_bf16 v[80:83], v[228:231], v[184:187], v[80:83]
L_pm5_N:
    s_waitcnt lgkmcnt(8)
    v_mfma_f32_16x16x32_bf16 v[80:83], v[224:227], v[176:179], v[80:83]
L_pm4_N:
    s_waitcnt lgkmcnt(6)
    v_mfma_f32_16x16x32_bf16 v[80:83], v[220:223], v[168:171], v[80:83]
L_pm3_N:
    s_waitcnt lgkmcnt(4)
    v_mfma_f32_16x16x32_bf16 v[80:83], v[216:219], v[160:163], v[80:83]
L_pm2_N:
    s_waitcnt lgkmcnt(2)
    v_mfma_f32_16x16x32_bf16 v[80:83], v[212:215], v[152:155], v[80:83]
L_pm1_N:
    s_waitcnt lgkmcnt(0)
    v_mfma_f32_16x16x32_bf16 v[80:83], v[208:211], v[144:147], v[80:83]
    s_nop 7
    v_min_u32 v80, -2, v80
    v_min_u32 v81, -2, v81
    v_min_u32 v82, -2, v82
    v_min_u32 v83, -2, v83
    s_mov_b64 exec, s[4:5]
    buffer_store_dwordx4 v[80:83], v13, s[44:47], s63 offen sc1
    s_mov_b64 exec, -1
    s_cmp_ge_u32 s49, s16
    s_cbranch_scc1 L_tail
    s_add_u32 s50, s50, 1
    s_cmp_ge_u32 s50, 8
    s_cbranch_scc1 L_tail
    s_waitcnt vmcnt(0) lgkmcnt(0)
    s_barrier
    s_branch L_fbloop
L_tail:
    s_add_u32 s49, s49, s97
    s_sub_u32 s49, s49, 8
    s_cmp_ge_u32 s49, s55
    s_cbranch_scc1 L_fin
    s_waitcnt vmcnt(0) lgkmcnt(0)
    s_barrier
    s_branch L_item
L_inact:
    s_waitcnt vmcnt(0)
    s_cmp_lg_u32 s14, 7
    s_cbranch_scc1 L_nosig_x
    v_mov_b32 v102, 1
    s_mov_b64 exec, 1
    s_lshl_b32 s56, s48, 5
    s_add_u32 s56, s56, s17
    s_sub_u32 s56, s56, 8
    buffer_store_byte v102, off, s[40:43], s56 sc1
    s_mov_b64 exec, -1
L_nosig_x:
L_fin:
L_exit:
    s_endpgm
.p2align 6
L_tab:
    .long 0x0c520c4e
    .long 0x2c542c50
    .long 0x4c564c52
    .long 0x6c586c54
    .long 0x0c5a0c56
    .long 0x2c5c2c58
    .long 0x4c5e4c5a
    .long 0x6c606c5c
    .long 0x8c968c92
    .long 0x2c982c94
    .long 0x4c9a4c96
    .long 0x6c9c6c98
    .long 0x8c9e8c9a
    .long 0x2ca02c9c
    .long 0x4ca24c9e
    .long 0x6ca46ca0
    .long 0x8cdc8cd8
    .long 0xacdeacda
    .long 0x4ce04cdc
    .long 0x6ce26cde
    .long 0x8ce48ce0
    .long 0xace6ace2
    .long 0x4ce84ce4
    .long 0x6cea6ce6
    .long 0x8d208d1c
    .long 0xad22ad1e
    .long 0xcd24cd20
    .long 0x6d266d22
    .long 0x8d288d24
    .long 0xad2aad26
    .long 0xcd2ccd28
    .long 0x6d2e6d2a
    .long 0x8d668d62
    .long 0xad68ad64
    .long 0xcd6acd66
    .long 0xed6ced68
    .long 0x8d6e8d6a
    .long 0xad70ad6c
    .long 0xcd72cd6e
    .long 0xed74ed70
    .long 0xedaaeda6
    .long 0xadacada8
    .long 0xcdaecdaa
    .long 0xedb0edac
    .long 0xedb2edae
    .long 0xadb4adb0
    .long 0xcdb6cdb2
    .long 0xedb8edb4
    .long 0xedd0edcc
    .long 0xedd2edce
    .long 0xcdd4cdd0
    .long 0xedd6edd2
    .long 0xedd8edd4
    .long 0xeddaedd6
    .long 0xcddccdd8
    .long 0xeddeedda
    .long 0xee14ee10
    .long 0xee16ee12
    .long 0xee18ee14
    .long 0xee1aee16
    .long 0xee1cee18
    .long 0xee1eee1a
    .long 0xee20ee1c
    .long 0xee22ee1e
    .long 0x00000000
    .long 0x20002000
    .long 0x40004000
    .long 0x60006000
    .long 0x80008000
    .long 0xa000a000
    .long 0xc000c000
    .long 0xe000e000
    .long 0x00000000
    .long 0x20002000
    .long 0x40004000
    .long 0x60006000
    .long 0x80008000
    .long 0xa000a000
    .long 0xc000c000
    .long 0xe000e000
    .long 0x00000000
    .long 0x20002000
    .long 0x40004000
    .long 0x60006000
    .long 0x80008000
    .long 0xa000a000
    .long 0xc000c000
    .long 0xe000e000
    .long 0x00000000
    .long 0x20002000
    .long 0x40004000
    .long 0x60006000
    .long 0x80008000
    .long 0xa000a000
    .long 0xc000c000
    .long 0xe000e000
    .long 0x00000000
    .long 0x20002000
    .long 0x40004000
    .long 0x60006000
    .long 0x80008000
    .long 0xa000a000
    .long 0xc000c000
    .long 0xe000e000
    .long 0x00000000
    .long 0x20002000
    .long 0x40004000
    .long 0x60006000
    .long 0x80008000
    .long 0xa000a000
    .long 0xc000c000
    .long 0xe000e000
    .long 0x00000000
    .long 0x20002000
    .long 0x40004000
    .long 0x60006000
    .long 0x80008000
    .long 0xa000a000
    .long 0xc000c000
    .long 0xe000e000
    .long 0x00000000
    .long 0x20002000
    .long 0x40004000
    .long 0x60006000
    .long 0x80000000
    .long 0xa0002000
    .long 0xc0004000
    .long 0xe0006000
    .long 0x00000000
    .long 0x20002000
    .long 0x40004000
    .long 0x60006000
    .long 0x00000000
    .long 0x20002000
    .long 0x40004000
    .long 0x60006000
    .long 0x00008000
    .long 0x20002000
    .long 0x40004000
    .long 0x60006000
    .long 0x00008000
    .long 0x20002000
    .long 0x40004000
    .long 0x60006000
    .long 0x80008000
    .long 0x2000a000
    .long 0x40004000
    .long 0x60006000
    .long 0x80008000
    .long 0x2000a000
    .long 0x40004000
    .long 0x60006000
    .long 0x80008000
    .long 0x2000a000
    .long 0x40004000
    .long 0x60006000
    .long 0x80008000
    .long 0x2000a000
    .long 0x40004000
    .long 0x60006000
    .long 0x80008000
    .long 0xa000a000
    .long 0x4000c000
    .long 0x60006000
    .long 0x80008000
    .long 0xa000a000
    .long 0x4000c000
    .long 0x60006000
    .long 0x80008000
    .long 0xa000a000
    .long 0x4000c000
    .long 0x60006000
    .long 0x80008000
    .long 0xa000a000
    .long 0x4000c000
    .long 0x60006000
    .long 0x80008000
    .long 0xa000a000
    .long 0xc000c000
    .long 0x6000e000
    .long 0x80008000
    .long 0xa000a000
    .long 0xc000c000
    .long 0x6000e000
    .long 0x80008000
    .long 0xa000a000
    .long 0xc000c000
    .long 0x6000e000
    .long 0x80008000
    .long 0xa000a000
    .long 0xc000c000
    .long 0x6000e000
    .long 0x80008000
    .long 0xa000a000
    .long 0xc000c000
    .long 0x6000e000
    .long 0x80008000
    .long 0xa000a000
    .long 0xc000c000
    .long 0x6000e000
    .long 0x8000e000
    .long 0xa000a000
    .long 0xc000c000
    .long 0xe000e000
    .long 0x8000e000
    .long 0xa000a000
    .long 0xc000c000
    .long 0xe000e000
    .long 0x8000e000
    .long 0xa000a000
    .long 0xc000c000
    .long 0xe000e000
    .long 0x8000e000
    .long 0xa000a000
    .long 0xc000c000
    .long 0xe000e000
    .long 0x8000e000
    .long 0xa000a000
    .long 0xc000c000
    .long 0xe000e000
    .long 0x8000e000
    .long 0xa000a000
    .long 0xc000c000
    .long 0xe000e000
    .long 0xe000e000
    .long 0xa000e000
    .long 0xc000c000
    .long 0xe000e000
    .long 0xe000e000
    .long 0xa000e000
    .long 0xc000c000
    .long 0xe000e000
    .long 0xe000e000
    .long 0xa000e000
    .long 0xc000e000
    .long 0xe000e000
    .long 0xe000e000
    .long 0xa000e000
    .long 0xc000e000
    .long 0xe000e000
    .long 0xe000e000
    .long 0xa000e000
    .long 0xc000e000
    .long 0xe000e000
    .long 0xe000e000
    .long 0xa000e000
    .long 0xc000e000
    .long 0xe000e000
    .long 0xe0000000
    .long 0xe0000000
    .long 0xc0000000
    .long 0xe0000000
    .long 0xe0000000
    .long 0xe0000000
    .long 0xc0000000
    .long 0xe0000000
    .long 0xe0000000
    .long 0xe0000000
    .long 0xc0000000
    .long 0xe0000000
    .long 0xe0000000
    .long 0xe0000000
    .long 0xc0000000
    .long 0xe0000000
    .long 0xe0000000
    .long 0xe0000000
    .long 0xe0000000
    .long 0xe0000000
    .long 0xe0000000
    .long 0xe0000000
    .long 0xe0000000
    .long 0xe0000000
    .long 0x00000000
    .long 0x00000000
    .long 0x00000000
    .long 0x00000000
    .long 0x00000000
    .long 0x00000000
    .long 0x00000000
    .long 0x00000000
.section .rodata,"a"
.p2align 6
.amdhsa_kernel standalone__paged_block_table_kv_radixattention__sampling_kernel
  .amdhsa_next_free_vgpr 256
  .amdhsa_next_free_sgpr 102
  .amdhsa_accum_offset 256
  .amdhsa_group_segment_fixed_size 0
  .amdhsa_kernarg_size 64
  .amdhsa_user_sgpr_count 2
  .amdhsa_user_sgpr_kernarg_segment_ptr 1
  .amdhsa_system_sgpr_workgroup_id_x 1
.end_amdhsa_kernel
```
